```python
import torch

def _softmax(x, axis=-1):
    return torch.softmax(x, dim=axis)

def _gelu(x):
    return torch.nn.functional.gelu(x, approximate='tanh')

def _silu(x):
    return torch.nn.functional.silu(x)

def _sigmoid(x):
    return torch.sigmoid(x)

def _layernorm(x, axis=-1, eps=1e-05):
    m = x.mean(dim=axis, keepdim=True)
    v = x.var(dim=axis, keepdim=True, unbiased=False)
    return (x - m) / torch.sqrt(v + eps)

def _scatter_add(tgt, idx, src, axis=0):
    return tgt.clone().index_add_(axis, idx, src)

def _segment_sum(src, seg, n):
    out = torch.zeros((n,) + src.shape[1:], dtype=src.dtype)
    return out.index_add_(0, seg, src)

def _pad(x, pw):
    flat = tuple((v for pair in reversed(pw) for v in pair))
    return torch.nn.functional.pad(x, flat)
kernel_name = 'standalone__kv_cache_quant_pre_rope_vs_post_rope__prompt'

def setup_inputs():

    _w = lambda a: (lambda t: t.to(torch.bfloat16) if t.is_floating_point() else t)(torch.as_tensor(a))
    B, Sq, Skv = (1, 2048, 2048)
    H, Dh0 = (4, 128)
    G = 32 if 32 > 0 else Dh0
    G = max(2, G // 2 * 2)
    Dh = max(G, Dh0 // G * G)
    Skv = max(Skv, Sq)
    ng = Dh // G
    bits = 8 if 8 > 1 else 4
    bits = max(2, min(8, bits))
    qmax = (1 << bits) - 1
    half = Dh // 2
    inv = 1.0 / 10000.0 ** (torch.arange(half) / max(1, half))
    ang_k = torch.arange(Skv)[:, None] * inv[None, :]
    ang_q = torch.arange(Skv - Sq, Skv)[:, None] * inv[None, :]
    kc = torch.cat([torch.cos(ang_k), torch.cos(ang_k)], dim=-1)
    ks = torch.cat([torch.sin(ang_k), torch.sin(ang_k)], dim=-1)
    qc = torch.cat([torch.cos(ang_q), torch.cos(ang_q)], dim=-1)
    qs = torch.cat([torch.sin(ang_q), torch.sin(ang_q)], dim=-1)
    qk_i = torch.randint(0, qmax + 1, (B, H, Skv, Dh)).to(torch.int32)
    qv_i = torch.randint(0, qmax + 1, (B, H, Skv, Dh)).to(torch.int32)
    ksc = torch.abs((lambda *s: torch.randn(*s, dtype=torch.bfloat16) * 0.05)(B, H, Skv, ng)) * 0.1 + 0.01
    kzp = torch.full((B, H, Skv, ng), qmax / 2.0)
    vsc = torch.abs((lambda *s: torch.randn(*s, dtype=torch.bfloat16) * 0.05)(B, H, Skv, ng)) * 0.1 + 0.01
    vzp = torch.full((B, H, Skv, ng), qmax / 2.0)
    return {'q': _w((lambda *s: torch.randn(*s, dtype=torch.bfloat16) * 0.8)(B, H, Sq, Dh) * 0.5), 'qk': _w(qk_i), 'k_scales': _w(ksc), 'k_zeros': _w(kzp), 'qv': _w(qv_i), 'v_scales': _w(vsc), 'v_zeros': _w(vzp), 'q_cos': _w(qc), 'q_sin': _w(qs), 'k_cos': _w(kc), 'k_sin': _w(ks)}

def reference(q, qk, k_scales, k_zeros, qv, v_scales, v_zeros, q_cos, q_sin, k_cos, k_sin):
    B, H, Sq, Dh = q.shape
    ng = k_scales.shape[-1]
    G = Dh // ng
    half = Dh // 2
    ks = (lambda x, n, axis: torch.repeat_interleave(x, n, dim=axis))(k_scales, G, axis=-1)
    kz = (lambda x, n, axis: torch.repeat_interleave(x, n, dim=axis))(k_zeros, G, axis=-1)
    k = ((lambda x, dt: x.to(dt))(qk, q.dtype) - kz) * ks
    vs = (lambda x, n, axis: torch.repeat_interleave(x, n, dim=axis))(v_scales, G, axis=-1)
    vz = (lambda x, n, axis: torch.repeat_interleave(x, n, dim=axis))(v_zeros, G, axis=-1)
    v = ((lambda x, dt: x.to(dt))(qv, q.dtype) - vz) * vs
    k1 = k[..., :half].clone()
    k2 = k[..., half:].clone()
    krh = torch.concatenate([-k2, k1], axis=-1)
    kr = k * k_cos[None, None, :, :] + krh * k_sin[None, None, :, :]
    q1 = q[..., :half].clone()
    q2 = q[..., half:].clone()
    qrh = torch.concatenate([-q2, q1], axis=-1)
    qr = q * q_cos[None, None, :, :] + qrh * q_sin[None, None, :, :]
    logits = torch.einsum('bhqd,bhkd->bhqk', qr, kr) * float(Dh) ** (-0.5)
    attn = _softmax(logits, axis=-1)
    out = torch.einsum('bhqk,bhkd->bhqd', attn, v)
    return out
```

```asm
; @launch grid=(256,1,1) block=(256,1,1) lds=90624
.amdgcn_target "amdgcn-amd-amdhsa--gfx950"
.text
.globl standalone__kv_cache_quant_pre_rope_vs_post_rope__prompt_kernel
.p2align 8
.type standalone__kv_cache_quant_pre_rope_vs_post_rope__prompt_kernel,@function
standalone__kv_cache_quant_pre_rope_vs_post_rope__prompt_kernel:
KSTART:
    s_cmp_ge_u32 s2, 256
    s_cbranch_scc1 A_end
    s_load_dwordx16 s[4:19], s[0:1], 0
    s_load_dwordx8 s[20:27], s[0:1], 64
    s_load_dwordx2 s[28:29], s[0:1], 104
    v_lshrrev_b32 v6, 6, v0
    v_and_b32 v0, 63, v0
    v_readfirstlane_b32 s48, v6
    s_getpc_b64 s[86:87]
L_pc:
    s_lshr_b32 s47, s2, 3
    s_lshl_b32 s47, s47, 2
    s_add_u32 s47, s47, s48
    s_and_b32 s47, s47, 15
    s_lshl_b32 s47, s47, 10
    s_sub_u32 s86, s86, L_pc-KSTART
    s_subb_u32 s87, s87, 0
    v_lshlrev_b32 v1, 4, v0
    v_add_u32 v16, s47, v1
    global_load_dwordx4 v[252:255], v16, s[86:87]
    s_and_b32 s89, s2, 7
    s_lshr_b32 s90, s2, 3
    s_lshr_b32 s49, s89, 1
    s_and_b32 s50, s89, 1
    s_lshl_b32 s50, s50, 1
    s_and_b32 s91, s90, 1
    s_add_u32 s50, s50, s91
    s_lshr_b32 s51, s90, 1
    v_and_b32 v6, 7, v0
    v_lshrrev_b32 v7, 3, v0
    v_and_b32 v8, 4, v7
    v_add_u32 v8, v7, v8
    v_lshlrev_b32 v9, 5, v6
    v_lshl_add_u32 v9, v8, 9, v9
    s_lshl_b32 s89, s50, 9
    s_lshl_b32 s90, s51, 5
    s_add_u32 s89, s89, s90
    s_and_b32 s90, s48, 1
    s_lshl_b32 s90, s90, 2
    s_lshr_b32 s91, s48, 1
    s_lshl_b32 s91, s91, 4
    s_add_u32 s90, s90, s91
    s_add_u32 s90, s90, s89
    s_lshl_b32 s91, s49, 11
    s_add_u32 s92, s91, s90
    s_lshl_b32 s40, s92, 9
    s_lshl_b32 s42, s92, 3
    v_add_u32 v10, s90, v8
    v_add_u32 v9, s40, v9
    v_lshlrev_b32 v11, 3, v8
    v_add_u32 v11, s42, v11
    v_and_b32 v12, 31, v0
    v_lshrrev_b32 v13, 5, v0
    s_lshr_b32 s43, s48, 1
    s_and_b32 s44, s48, 1
    s_add_u32 s91, s91, s89
    s_lshl_b32 s45, s43, 4
    s_add_u32 s45, s45, s91
    s_lshl_b32 s45, s45, 9
    s_lshl_b32 s46, s44, 8
    s_add_u32 s45, s45, s46
    v_lshrrev_b32 v14, 4, v0
    v_lshlrev_b32 v14, 9, v14
    v_and_b32 v15, 15, v0
    v_lshl_add_u32 v14, v15, 4, v14
    v_add_u32 v14, s45, v14
    s_lshl_b32 s46, s91, 3
    v_lshlrev_b32 v15, 3, v12
    v_add_u32 v15, s46, v15
    s_lshl_b32 s46, s48, 12
    s_add_u32 s46, s46, 33280
    s_waitcnt lgkmcnt(0)
    global_load_dwordx2 v[160:161], v11, s[8:9]
    global_load_dwordx2 v[162:163], v11, s[10:11]
    global_load_dwordx2 v[184:185], v15, s[14:15]
    global_load_dwordx2 v[186:187], v15, s[16:17]
    global_load_dwordx4 v[128:131], v9, s[6:7]
    global_load_dwordx4 v[132:135], v9, s[6:7] offset:16
    global_load_dwordx4 v[136:139], v9, s[6:7] offset:256
    global_load_dwordx4 v[140:143], v9, s[6:7] offset:272
    v_lshlrev_b32 v17, 4, v6
    v_lshl_add_u32 v17, v7, 8, v17
    s_lshl_b32 s89, s51, 7
    s_lshl_b32 s90, s48, 3
    s_add_u32 s89, s89, s90
    s_lshl_b32 s92, s89, 8
    s_lshl_b32 s90, s49, 19
    s_add_u32 s4, s4, s90
    s_addc_u32 s5, s5, 0
    s_add_u32 m0, s46, 0
    s_nop 0
    global_load_lds_dwordx4 v14, s[12:13]
    s_add_u32 m0, s46, 1024
    v_add_u32 v14, 2048, v14
    global_load_lds_dwordx4 v14, s[12:13]
    s_add_u32 m0, s46, 2048
    v_add_u32 v14, 2048, v14
    global_load_lds_dwordx4 v14, s[12:13]
    s_add_u32 m0, s46, 3072
    v_add_u32 v14, 2048, v14
    global_load_lds_dwordx4 v14, s[12:13]
    s_xor_b32 s90, s50, 2
    s_lshl_b32 s90, s90, 13
    s_add_u32 s90, s90, s92
    v_add_u32 v18, s90, v17
    s_xor_b32 s90, s50, 3
    s_lshl_b32 s90, s90, 13
    s_add_u32 s90, s90, s92
    v_add_u32 v19, s90, v17
    s_xor_b32 s90, s50, 1
    s_lshl_b32 s90, s90, 13
    s_add_u32 s90, s90, s92
    v_add_u32 v20, s90, v17
    s_xor_b32 s90, s50, 0
    s_lshl_b32 s90, s90, 13
    s_add_u32 s90, s90, s92
    v_add_u32 v28, s90, v17
    s_mov_b32 s32, s28
    s_and_b32 s33, s29, 0xffff
    s_mov_b32 s34, 16777216
    s_mov_b32 s35, 0x20000
    s_mov_b32 s36, s26
    s_and_b32 s37, s27, 0xffff
    s_mov_b32 s38, 2097152
    s_mov_b32 s39, 0x20000
    s_lshl_b32 s52, s49, 2
    s_add_u32 s52, s52, s50
    s_lshl_b32 s93, s52, 7
    s_add_u32 s93, s93, 14745600
    s_lshl_b32 s53, s49, 4
    s_add_u32 s53, s53, s51
    s_lshl_b32 s94, s53, 7
    s_add_u32 s94, s94, 14811136
    s_load_dwordx2 s[54:55], s[28:29], s93
    s_load_dwordx2 s[56:57], s[28:29], s94
    s_mov_b32 s81, 0xffff0000
    s_mov_b32 s40, 0x05040100
    s_mov_b32 s41, 0x07060302
    s_mov_b32 s42, 0x3e0293ee
    s_mov_b32 s88, 0
    s_mov_b32 s82, 0x2b800000
    s_mov_b32 s83, 0x28000000
    v_cvt_f32_u32 v31, v6
    v_mul_f32 v31, 0xbfd49a78, v31
    v_exp_f32 v31, v31
    v_cvt_f32_u32 v224, v10
    v_mul_f32 v224, v224, v31
    v_mul_f32 v208, 0x3e22f983, v224
    v_mul_f32 v209, 0x3e0d2158, v224
    v_mul_f32 v210, 0x3df46d71, v224
    v_mul_f32 v211, 0x3dd3aa5e, v224
    v_mul_f32 v212, 0x3db74b76, v224
    v_mul_f32 v213, 0x3d9eba0b, v224
    v_mul_f32 v214, 0x3d8973a2, v224
    v_mul_f32 v215, 0x3d6e0e78, v224
    v_fract_f32 v208, v208
    v_fract_f32 v209, v209
    v_fract_f32 v210, v210
    v_fract_f32 v211, v211
    v_fract_f32 v212, v212
    v_fract_f32 v213, v213
    v_fract_f32 v214, v214
    v_fract_f32 v215, v215
    v_sin_f32 v216, v208
    v_sin_f32 v217, v209
    v_sin_f32 v218, v210
    v_sin_f32 v219, v211
    v_sin_f32 v220, v212
    v_sin_f32 v221, v213
    v_sin_f32 v222, v214
    v_sin_f32 v223, v215
    v_cos_f32 v208, v208
    v_cos_f32 v209, v209
    v_cos_f32 v210, v210
    v_cos_f32 v211, v211
    v_cos_f32 v212, v212
    v_cos_f32 v213, v213
    v_cos_f32 v214, v214
    v_cos_f32 v215, v215
    v_cvt_pk_bf16_f32 v144, v208, v216
    v_cvt_pk_bf16_f32 v152, v216, v208
    v_cvt_pk_bf16_f32 v145, v209, v217
    v_cvt_pk_bf16_f32 v153, v217, v209
    v_cvt_pk_bf16_f32 v146, v210, v218
    v_cvt_pk_bf16_f32 v154, v218, v210
    v_cvt_pk_bf16_f32 v147, v211, v219
    v_cvt_pk_bf16_f32 v155, v219, v211
    v_cvt_pk_bf16_f32 v148, v212, v220
    v_cvt_pk_bf16_f32 v156, v220, v212
    v_cvt_pk_bf16_f32 v149, v213, v221
    v_cvt_pk_bf16_f32 v157, v221, v213
    v_cvt_pk_bf16_f32 v150, v214, v222
    v_cvt_pk_bf16_f32 v158, v222, v214
    v_cvt_pk_bf16_f32 v151, v215, v223
    v_cvt_pk_bf16_f32 v159, v223, v215
    s_mov_b32 s31, s89
    v_lshlrev_b32 v22, 10, v6
    v_lshl_add_u32 v22, v7, 4, v22
    s_lshl_b32 s89, s52, 4
    s_add_u32 s89, s89, s51
    s_lshl_b32 s95, s89, 7
    s_add_u32 s95, s95, 14680064
    s_lshl_b32 s89, s89, 13
    s_lshl_b32 s90, s48, 7
    s_add_u32 s46, s89, s90
    s_lshl_b32 s89, s52, 2
    s_and_b32 s90, s51, 3
    s_add_u32 s89, s89, s90
    s_lshl_b32 s89, s89, 2
    s_lshl_b32 s90, s44, 1
    s_add_u32 s89, s89, s90
    s_lshl_b32 s89, s89, 13
    s_lshr_b32 s90, s51, 2
    s_lshl_b32 s90, s90, 1
    s_add_u32 s90, s90, s43
    s_lshl_b32 s90, s90, 10
    s_add_u32 s89, s89, s90
    s_add_u32 s47, s89, 2097152
    s_add_u32 s45, s47, 8192
    s_lshl_b32 s89, s48, 9
    s_add_u32 s89, s89, 53760
    v_lshlrev_b32 v23, 3, v12
    v_add_u32 v23, s89, v23
    s_lshl_b32 s90, s43, 7
    s_add_u32 s89, s89, s90
    s_lshl_b32 s90, s44, 2
    s_add_u32 s89, s89, s90
    v_lshlrev_b32 v24, 6, v13
    v_add_u32 v24, s89, v24
    s_lshl_b32 s89, s48, 12
    s_add_u32 s89, s89, 33280
    v_lshlrev_b32 v21, 11, v13
    v_lshl_add_u32 v21, v12, 2, v21
    v_add_u32 v21, s89, v21
    v_add_u32 v29, 128, v21
    v_mul_u32_u24 v25, 1040, v6
    v_lshl_add_u32 v25, v7, 4, v25
    s_lshl_b32 s89, s48, 7
    v_add_u32 v25, s89, v25
    v_lshrrev_b32 v26, 2, v6
    v_lshlrev_b32 v26, 4, v26
    v_sub_u32 v26, 16, v26
    s_lshl_b32 s89, s52, 4
    s_lshl_b32 s90, s48, 2
    s_add_u32 s89, s89, s90
    s_lshl_b32 s89, s89, 13
    s_add_u32 s58, s89, 0
    s_add_u32 s59, s89, 4096
    s_add_u32 s60, s89, 8192
    s_add_u32 s61, s89, 12288
    s_add_u32 s62, s89, 16384
    s_add_u32 s63, s89, 20480
    s_add_u32 s64, s89, 24576
    s_add_u32 s65, s89, 28672
    s_lshl_b32 s89, s52, 17
    s_lshl_b32 s90, s48, 13
    s_add_u32 s89, s89, s90
    s_add_u32 s89, s89, 2097152
    s_add_u32 s66, s89, 0
    s_add_u32 s67, s89, 4096
    s_add_u32 s68, s89, 32768
    s_add_u32 s69, s89, 36864
    s_add_u32 s70, s89, 65536
    s_add_u32 s71, s89, 69632
    s_add_u32 s72, s89, 98304
    s_add_u32 s73, s89, 102400
    s_xor_b32 s89, s50, 2
    s_lshl_b32 s90, s53, 2
    s_add_u32 s89, s89, s90
    s_mul_i32 s89, s89, 3
    s_add_u32 s89, s89, 0
    s_lshl_b32 s89, s89, 2
    s_add_u32 s89, s89, s48
    s_mul_i32 s89, s89, 3072
    s_add_u32 s74, s89, 4194304
    s_xor_b32 s89, s50, 3
    s_lshl_b32 s90, s53, 2
    s_add_u32 s89, s89, s90
    s_mul_i32 s89, s89, 3
    s_add_u32 s89, s89, 1
    s_lshl_b32 s89, s89, 2
    s_add_u32 s89, s89, s48
    s_mul_i32 s89, s89, 3072
    s_add_u32 s75, s89, 4194304
    s_xor_b32 s89, s50, 1
    s_lshl_b32 s90, s53, 2
    s_add_u32 s89, s89, s90
    s_mul_i32 s89, s89, 3
    s_add_u32 s89, s89, 2
    s_lshl_b32 s89, s89, 2
    s_add_u32 s89, s89, s48
    s_mul_i32 s89, s89, 3072
    s_add_u32 s76, s89, 4194304
    s_lshl_b32 s90, s53, 2
    s_add_u32 s90, s90, s50
    s_mul_i32 s90, s90, 3
    s_add_u32 s89, s90, 0
    s_lshl_b32 s89, s89, 2
    s_add_u32 s89, s89, s48
    s_mul_i32 s89, s89, 3072
    s_add_u32 s77, s89, 4194304
    s_add_u32 s89, s90, 1
    s_lshl_b32 s89, s89, 2
    s_add_u32 s89, s89, s48
    s_mul_i32 s89, s89, 3072
    s_add_u32 s78, s89, 4194304
    s_add_u32 s89, s90, 2
    s_lshl_b32 s89, s89, 2
    s_add_u32 s89, s89, s48
    s_mul_i32 s89, s89, 3072
    s_add_u32 s79, s89, 4194304
    s_lshl_b32 s89, s49, 11
    s_lshl_b32 s90, s51, 7
    s_add_u32 s89, s89, s90
    s_lshl_b32 s90, s50, 5
    s_add_u32 s89, s89, s90
    s_lshl_b32 s89, s89, 8
    s_lshl_b32 s90, s48, 6
    s_add_u32 s80, s89, s90
    s_lshl_b32 s89, s48, 11
    s_add_u32 s89, s89, 33280
    v_add_u32 v2, s89, v1
    v_lshlrev_b32 v4, 2, v12
    v_add_u32 v4, 49664, v4
    s_lshl_b32 s89, s48, 8
    s_add_u32 s89, s89, 49664
    v_lshlrev_b32 v3, 2, v0
    v_add_u32 v3, s89, v3
    v_lshlrev_b32 v27, 2, v0
    v_add_u32 v27, 53760, v27
    v_cmp_gt_u32 vcc, 16, v0
    s_nop 1
    v_cndmask_b32 v3, v27, v3, vcc
    v_lshlrev_b32 v5, 8, v12
    v_lshl_add_u32 v5, v13, 4, v5
    s_waitcnt vmcnt(9)
    ds_write_b64 v23, v[184:185] offset:0
    s_waitcnt vmcnt(8)
    ds_write_b64 v23, v[186:187] offset:256
    ds_read2_b32 v[32:33], v24 offset0:0 offset1:2
    ds_read2_b32 v[34:35], v24 offset0:4 offset1:6
    ds_read2_b32 v[36:37], v24 offset0:8 offset1:10
    ds_read2_b32 v[38:39], v24 offset0:12 offset1:14
    ds_read2_b32 v[56:57], v24 offset0:64 offset1:66
    ds_read2_b32 v[58:59], v24 offset0:68 offset1:70
    ds_read2_b32 v[60:61], v24 offset0:72 offset1:74
    ds_read2_b32 v[62:63], v24 offset0:76 offset1:78
    v_lshlrev_b32 v196, v26, v160
    v_and_b32 v196, s81, v196
    v_lshlrev_b32 v197, v26, v161
    v_and_b32 v197, s81, v197
    v_lshlrev_b32 v198, v26, v162
    v_and_b32 v198, s81, v198
    v_lshlrev_b32 v199, v26, v163
    v_and_b32 v199, s81, v199
    v_mul_f32 v196, s42, v196
    v_mul_f32 v197, s42, v197
    v_mul_f32_e64 v198, -v198, v196
    v_mul_f32_e64 v199, -v199, v197
    s_waitcnt vmcnt(7)
    v_cvt_f32_i32 v128, v128
    s_waitcnt vmcnt(5)
    v_cvt_f32_i32 v136, v136
    v_cvt_f32_i32 v129, v129
    v_cvt_f32_i32 v137, v137
    v_cvt_f32_i32 v130, v130
    v_cvt_f32_i32 v138, v138
    v_cvt_f32_i32 v131, v131
    v_cvt_f32_i32 v139, v139
    v_cvt_f32_i32 v132, v132
    s_waitcnt vmcnt(4)
    v_cvt_f32_i32 v140, v140
    v_cvt_f32_i32 v133, v133
    v_cvt_f32_i32 v141, v141
    v_cvt_f32_i32 v134, v134
    v_cvt_f32_i32 v142, v142
    v_cvt_f32_i32 v135, v135
    v_cvt_f32_i32 v143, v143
    v_fma_f32 v128, v128, v196, v198
    v_fma_f32 v136, v136, v197, v199
    v_fma_f32 v129, v129, v196, v198
    v_fma_f32 v137, v137, v197, v199
    v_fma_f32 v130, v130, v196, v198
    v_fma_f32 v138, v138, v197, v199
    v_fma_f32 v131, v131, v196, v198
    v_fma_f32 v139, v139, v197, v199
    v_fma_f32 v132, v132, v196, v198
    v_fma_f32 v140, v140, v197, v199
    v_fma_f32 v133, v133, v196, v198
    v_fma_f32 v141, v141, v197, v199
    v_fma_f32 v134, v134, v196, v198
    v_fma_f32 v142, v142, v197, v199
    v_fma_f32 v135, v135, v196, v198
    v_fma_f32 v143, v143, v197, v199
    v_cvt_pk_bf16_f32 v200, v128, v136
    v_cvt_pk_bf16_f32 v201, v129, v137
    v_cvt_pk_bf16_f32 v202, v130, v138
    v_cvt_pk_bf16_f32 v203, v131, v139
    v_cvt_pk_bf16_f32 v204, v132, v140
    v_cvt_pk_bf16_f32 v205, v133, v141
    v_cvt_pk_bf16_f32 v206, v134, v142
    v_cvt_pk_bf16_f32 v207, v135, v143
    v_dot2_f32_bf16 v224, v200, v144, 0 neg_hi:[0,1,0]
    v_dot2_f32_bf16 v232, v200, v152, 0
    v_dot2_f32_bf16 v225, v201, v145, 0 neg_hi:[0,1,0]
    v_dot2_f32_bf16 v233, v201, v153, 0
    v_dot2_f32_bf16 v226, v202, v146, 0 neg_hi:[0,1,0]
    v_dot2_f32_bf16 v234, v202, v154, 0
    v_dot2_f32_bf16 v227, v203, v147, 0 neg_hi:[0,1,0]
    v_dot2_f32_bf16 v235, v203, v155, 0
    v_dot2_f32_bf16 v228, v204, v148, 0 neg_hi:[0,1,0]
    v_dot2_f32_bf16 v236, v204, v156, 0
    v_dot2_f32_bf16 v229, v205, v149, 0 neg_hi:[0,1,0]
    v_dot2_f32_bf16 v237, v205, v157, 0
    v_dot2_f32_bf16 v230, v206, v150, 0 neg_hi:[0,1,0]
    v_dot2_f32_bf16 v238, v206, v158, 0
    v_dot2_f32_bf16 v231, v207, v151, 0 neg_hi:[0,1,0]
    v_dot2_f32_bf16 v239, v207, v159, 0
    v_cvt_pk_bf16_f32 v240, v224, v225
    v_cvt_pk_bf16_f32 v241, v226, v227
    v_cvt_pk_bf16_f32 v242, v232, v233
    v_cvt_pk_bf16_f32 v243, v234, v235
    v_cvt_pk_bf16_f32 v244, v228, v229
    v_cvt_pk_bf16_f32 v245, v230, v231
    v_cvt_pk_bf16_f32 v246, v236, v237
    v_cvt_pk_bf16_f32 v247, v238, v239
    buffer_store_dwordx4 v[240:243], v22, s[32:35], s46 offen sc1
    buffer_store_dwordx4 v[244:247], v22, s[32:35], s46 offen offset:512 sc1
    s_waitcnt vmcnt(2)
    s_nop 0
    ds_read2st64_b32 v[168:169], v21 offset0:0 offset1:1
    ds_read2st64_b32 v[170:171], v21 offset0:2 offset1:3
    ds_read2st64_b32 v[172:173], v21 offset0:4 offset1:5
    ds_read2st64_b32 v[174:175], v21 offset0:6 offset1:7
    ds_read2st64_b32 v[176:177], v29 offset0:0 offset1:1
    ds_read2st64_b32 v[178:179], v29 offset0:2 offset1:3
    ds_read2st64_b32 v[180:181], v29 offset0:4 offset1:5
    ds_read2st64_b32 v[182:183], v29 offset0:6 offset1:7
    s_waitcnt lgkmcnt(7)
    v_cvt_f32_i32 v168, v168
    v_cvt_f32_i32 v169, v169
    s_waitcnt lgkmcnt(6)
    v_cvt_f32_i32 v170, v170
    v_cvt_f32_i32 v171, v171
    s_waitcnt lgkmcnt(5)
    v_cvt_f32_i32 v172, v172
    v_cvt_f32_i32 v173, v173
    s_waitcnt lgkmcnt(4)
    v_cvt_f32_i32 v174, v174
    v_cvt_f32_i32 v175, v175
    s_waitcnt lgkmcnt(3)
    v_cvt_f32_i32 v176, v176
    v_cvt_f32_i32 v177, v177
    s_waitcnt lgkmcnt(2)
    v_cvt_f32_i32 v178, v178
    v_cvt_f32_i32 v179, v179
    s_waitcnt lgkmcnt(1)
    v_cvt_f32_i32 v180, v180
    v_cvt_f32_i32 v181, v181
    s_waitcnt lgkmcnt(0)
    v_cvt_f32_i32 v182, v182
    v_cvt_f32_i32 v183, v183
    v_lshlrev_b32 v144, 16, v32
    v_lshlrev_b32 v145, 16, v56
    v_sub_f32 v168, v168, v145
    v_mul_f32 v168, v168, v144
    v_lshlrev_b32 v144, 16, v33
    v_lshlrev_b32 v145, 16, v57
    v_sub_f32 v169, v169, v145
    v_mul_f32 v169, v169, v144
    v_lshlrev_b32 v144, 16, v34
    v_lshlrev_b32 v145, 16, v58
    v_sub_f32 v170, v170, v145
    v_mul_f32 v170, v170, v144
    v_lshlrev_b32 v144, 16, v35
    v_lshlrev_b32 v145, 16, v59
    v_sub_f32 v171, v171, v145
    v_mul_f32 v171, v171, v144
    v_lshlrev_b32 v144, 16, v36
    v_lshlrev_b32 v145, 16, v60
    v_sub_f32 v172, v172, v145
    v_mul_f32 v172, v172, v144
    v_lshlrev_b32 v144, 16, v37
    v_lshlrev_b32 v145, 16, v61
    v_sub_f32 v173, v173, v145
    v_mul_f32 v173, v173, v144
    v_lshlrev_b32 v144, 16, v38
    v_lshlrev_b32 v145, 16, v62
    v_sub_f32 v174, v174, v145
    v_mul_f32 v174, v174, v144
    v_lshlrev_b32 v144, 16, v39
    v_lshlrev_b32 v145, 16, v63
    v_sub_f32 v175, v175, v145
    v_mul_f32 v175, v175, v144
    v_cvt_pk_bf16_f32 v248, v168, v169
    v_cvt_pk_bf16_f32 v249, v170, v171
    v_cvt_pk_bf16_f32 v250, v172, v173
    v_cvt_pk_bf16_f32 v251, v174, v175
    v_and_b32 v144, s81, v32
    v_and_b32 v145, s81, v56
    v_sub_f32 v176, v176, v145
    v_mul_f32 v176, v176, v144
    v_and_b32 v144, s81, v33
    v_and_b32 v145, s81, v57
    v_sub_f32 v177, v177, v145
    v_mul_f32 v177, v177, v144
    v_and_b32 v144, s81, v34
    v_and_b32 v145, s81, v58
    v_sub_f32 v178, v178, v145
    v_mul_f32 v178, v178, v144
    v_and_b32 v144, s81, v35
    v_and_b32 v145, s81, v59
    v_sub_f32 v179, v179, v145
    v_mul_f32 v179, v179, v144
    v_and_b32 v144, s81, v36
    v_and_b32 v145, s81, v60
    v_sub_f32 v180, v180, v145
    v_mul_f32 v180, v180, v144
    v_and_b32 v144, s81, v37
    v_and_b32 v145, s81, v61
    v_sub_f32 v181, v181, v145
    v_mul_f32 v181, v181, v144
    v_and_b32 v144, s81, v38
    v_and_b32 v145, s81, v62
    v_sub_f32 v182, v182, v145
    v_mul_f32 v182, v182, v144
    v_and_b32 v144, s81, v39
    v_and_b32 v145, s81, v63
    v_sub_f32 v183, v183, v145
    v_mul_f32 v183, v183, v144
    v_cvt_pk_bf16_f32 v148, v176, v177
    v_cvt_pk_bf16_f32 v149, v178, v179
    v_cvt_pk_bf16_f32 v150, v180, v181
    v_cvt_pk_bf16_f32 v151, v182, v183
    buffer_store_dwordx4 v[248:251], v1, s[32:35], s47 offen sc1
    buffer_store_dwordx4 v[148:151], v1, s[32:35], s45 offen sc1
    global_load_dwordx4 v[32:35], v18, s[4:5]
    global_load_dwordx4 v[36:39], v18, s[4:5] offset:128
    global_load_dwordx4 v[56:59], v19, s[4:5]
    global_load_dwordx4 v[60:63], v19, s[4:5] offset:128
    global_load_dwordx4 v[80:83], v20, s[4:5]
    global_load_dwordx4 v[84:87], v20, s[4:5] offset:128
    global_load_dwordx4 v[104:107], v28, s[4:5]
    global_load_dwordx4 v[108:111], v28, s[4:5] offset:128
    s_xor_b32 s90, s50, 2
    s_lshl_b32 s90, s90, 5
    s_add_u32 s90, s90, s31
    v_add_u32 v30, s90, v7
    v_cvt_f32_u32 v224, v30
    v_mul_f32 v224, v224, v31
    v_mul_f32 v208, 0x3e22f983, v224
    v_mul_f32 v209, 0x3e0d2158, v224
    v_mul_f32 v210, 0x3df46d71, v224
    v_mul_f32 v211, 0x3dd3aa5e, v224
    v_mul_f32 v212, 0x3db74b76, v224
    v_mul_f32 v213, 0x3d9eba0b, v224
    v_mul_f32 v214, 0x3d8973a2, v224
    v_mul_f32 v215, 0x3d6e0e78, v224
    v_fract_f32 v208, v208
    v_fract_f32 v209, v209
    v_fract_f32 v210, v210
    v_fract_f32 v211, v211
    v_fract_f32 v212, v212
    v_fract_f32 v213, v213
    v_fract_f32 v214, v214
    v_fract_f32 v215, v215
    v_sin_f32 v216, v208
    v_sin_f32 v217, v209
    v_sin_f32 v218, v210
    v_sin_f32 v219, v211
    v_sin_f32 v220, v212
    v_sin_f32 v221, v213
    v_sin_f32 v222, v214
    v_sin_f32 v223, v215
    v_cos_f32 v208, v208
    v_cos_f32 v209, v209
    v_cos_f32 v210, v210
    v_cos_f32 v211, v211
    v_cos_f32 v212, v212
    v_cos_f32 v213, v213
    v_cos_f32 v214, v214
    v_cos_f32 v215, v215
    v_cvt_pk_bf16_f32 v40, v208, v216
    v_cvt_pk_bf16_f32 v48, v216, v208
    v_cvt_pk_bf16_f32 v41, v209, v217
    v_cvt_pk_bf16_f32 v49, v217, v209
    v_cvt_pk_bf16_f32 v42, v210, v218
    v_cvt_pk_bf16_f32 v50, v218, v210
    v_cvt_pk_bf16_f32 v43, v211, v219
    v_cvt_pk_bf16_f32 v51, v219, v211
    v_cvt_pk_bf16_f32 v44, v212, v220
    v_cvt_pk_bf16_f32 v52, v220, v212
    v_cvt_pk_bf16_f32 v45, v213, v221
    v_cvt_pk_bf16_f32 v53, v221, v213
    v_cvt_pk_bf16_f32 v46, v214, v222
    v_cvt_pk_bf16_f32 v54, v222, v214
    v_cvt_pk_bf16_f32 v47, v215, v223
    v_cvt_pk_bf16_f32 v55, v223, v215
    s_xor_b32 s90, s50, 3
    s_lshl_b32 s90, s90, 5
    s_add_u32 s90, s90, s31
    v_add_u32 v30, s90, v7
    v_cvt_f32_u32 v224, v30
    v_mul_f32 v224, v224, v31
    v_mul_f32 v208, 0x3e22f983, v224
    v_mul_f32 v209, 0x3e0d2158, v224
    v_mul_f32 v210, 0x3df46d71, v224
    v_mul_f32 v211, 0x3dd3aa5e, v224
    v_mul_f32 v212, 0x3db74b76, v224
    v_mul_f32 v213, 0x3d9eba0b, v224
    v_mul_f32 v214, 0x3d8973a2, v224
    v_mul_f32 v215, 0x3d6e0e78, v224
    v_fract_f32 v208, v208
    v_fract_f32 v209, v209
    v_fract_f32 v210, v210
    v_fract_f32 v211, v211
    v_fract_f32 v212, v212
    v_fract_f32 v213, v213
    v_fract_f32 v214, v214
    v_fract_f32 v215, v215
    v_sin_f32 v216, v208
    v_sin_f32 v217, v209
    v_sin_f32 v218, v210
    v_sin_f32 v219, v211
    v_sin_f32 v220, v212
    v_sin_f32 v221, v213
    v_sin_f32 v222, v214
    v_sin_f32 v223, v215
    v_cos_f32 v208, v208
    v_cos_f32 v209, v209
    v_cos_f32 v210, v210
    v_cos_f32 v211, v211
    v_cos_f32 v212, v212
    v_cos_f32 v213, v213
    v_cos_f32 v214, v214
    v_cos_f32 v215, v215
    v_cvt_pk_bf16_f32 v64, v208, v216
    v_cvt_pk_bf16_f32 v72, v216, v208
    v_cvt_pk_bf16_f32 v65, v209, v217
    v_cvt_pk_bf16_f32 v73, v217, v209
    v_cvt_pk_bf16_f32 v66, v210, v218
    v_cvt_pk_bf16_f32 v74, v218, v210
    v_cvt_pk_bf16_f32 v67, v211, v219
    v_cvt_pk_bf16_f32 v75, v219, v211
    v_cvt_pk_bf16_f32 v68, v212, v220
    v_cvt_pk_bf16_f32 v76, v220, v212
    v_cvt_pk_bf16_f32 v69, v213, v221
    v_cvt_pk_bf16_f32 v77, v221, v213
    v_cvt_pk_bf16_f32 v70, v214, v222
    v_cvt_pk_bf16_f32 v78, v222, v214
    v_cvt_pk_bf16_f32 v71, v215, v223
    v_cvt_pk_bf16_f32 v79, v223, v215
    s_xor_b32 s90, s50, 1
    s_lshl_b32 s90, s90, 5
    s_add_u32 s90, s90, s31
    v_add_u32 v30, s90, v7
    v_cvt_f32_u32 v224, v30
    v_mul_f32 v224, v224, v31
    v_mul_f32 v208, 0x3e22f983, v224
    v_mul_f32 v209, 0x3e0d2158, v224
    v_mul_f32 v210, 0x3df46d71, v224
    v_mul_f32 v211, 0x3dd3aa5e, v224
    v_mul_f32 v212, 0x3db74b76, v224
    v_mul_f32 v213, 0x3d9eba0b, v224
    v_mul_f32 v214, 0x3d8973a2, v224
    v_mul_f32 v215, 0x3d6e0e78, v224
    v_fract_f32 v208, v208
    v_fract_f32 v209, v209
    v_fract_f32 v210, v210
    v_fract_f32 v211, v211
    v_fract_f32 v212, v212
    v_fract_f32 v213, v213
    v_fract_f32 v214, v214
    v_fract_f32 v215, v215
    v_sin_f32 v216, v208
    v_sin_f32 v217, v209
    v_sin_f32 v218, v210
    v_sin_f32 v219, v211
    v_sin_f32 v220, v212
    v_sin_f32 v221, v213
    v_sin_f32 v222, v214
    v_sin_f32 v223, v215
    v_cos_f32 v208, v208
    v_cos_f32 v209, v209
    v_cos_f32 v210, v210
    v_cos_f32 v211, v211
    v_cos_f32 v212, v212
    v_cos_f32 v213, v213
    v_cos_f32 v214, v214
    v_cos_f32 v215, v215
    v_cvt_pk_bf16_f32 v88, v208, v216
    v_cvt_pk_bf16_f32 v96, v216, v208
    v_cvt_pk_bf16_f32 v89, v209, v217
    v_cvt_pk_bf16_f32 v97, v217, v209
    v_cvt_pk_bf16_f32 v90, v210, v218
    v_cvt_pk_bf16_f32 v98, v218, v210
    v_cvt_pk_bf16_f32 v91, v211, v219
    v_cvt_pk_bf16_f32 v99, v219, v211
    v_cvt_pk_bf16_f32 v92, v212, v220
    v_cvt_pk_bf16_f32 v100, v220, v212
    v_cvt_pk_bf16_f32 v93, v213, v221
    v_cvt_pk_bf16_f32 v101, v221, v213
    v_cvt_pk_bf16_f32 v94, v214, v222
    v_cvt_pk_bf16_f32 v102, v222, v214
    v_cvt_pk_bf16_f32 v95, v215, v223
    v_cvt_pk_bf16_f32 v103, v223, v215
    s_xor_b32 s90, s50, 0
    s_lshl_b32 s90, s90, 5
    s_add_u32 s90, s90, s31
    v_add_u32 v30, s90, v7
    v_cvt_f32_u32 v224, v30
    v_mul_f32 v224, v224, v31
    v_mul_f32 v208, 0x3e22f983, v224
    v_mul_f32 v209, 0x3e0d2158, v224
    v_mul_f32 v210, 0x3df46d71, v224
    v_mul_f32 v211, 0x3dd3aa5e, v224
    v_mul_f32 v212, 0x3db74b76, v224
    v_mul_f32 v213, 0x3d9eba0b, v224
    v_mul_f32 v214, 0x3d8973a2, v224
    v_mul_f32 v215, 0x3d6e0e78, v224
    v_fract_f32 v208, v208
    v_fract_f32 v209, v209
    v_fract_f32 v210, v210
    v_fract_f32 v211, v211
    v_fract_f32 v212, v212
    v_fract_f32 v213, v213
    v_fract_f32 v214, v214
    v_fract_f32 v215, v215
    v_sin_f32 v216, v208
    v_sin_f32 v217, v209
    v_sin_f32 v218, v210
    v_sin_f32 v219, v211
    v_sin_f32 v220, v212
    v_sin_f32 v221, v213
    v_sin_f32 v222, v214
    v_sin_f32 v223, v215
    v_cos_f32 v208, v208
    v_cos_f32 v209, v209
    v_cos_f32 v210, v210
    v_cos_f32 v211, v211
    v_cos_f32 v212, v212
    v_cos_f32 v213, v213
    v_cos_f32 v214, v214
    v_cos_f32 v215, v215
    v_cvt_pk_bf16_f32 v112, v208, v216
    v_cvt_pk_bf16_f32 v120, v216, v208
    v_cvt_pk_bf16_f32 v113, v209, v217
    v_cvt_pk_bf16_f32 v121, v217, v209
    v_cvt_pk_bf16_f32 v114, v210, v218
    v_cvt_pk_bf16_f32 v122, v218, v210
    v_cvt_pk_bf16_f32 v115, v211, v219
    v_cvt_pk_bf16_f32 v123, v219, v211
    v_cvt_pk_bf16_f32 v116, v212, v220
    v_cvt_pk_bf16_f32 v124, v220, v212
    v_cvt_pk_bf16_f32 v117, v213, v221
    v_cvt_pk_bf16_f32 v125, v221, v213
    v_cvt_pk_bf16_f32 v118, v214, v222
    v_cvt_pk_bf16_f32 v126, v222, v214
    v_cvt_pk_bf16_f32 v119, v215, v223
    v_cvt_pk_bf16_f32 v127, v223, v215
    s_waitcnt lgkmcnt(0)
    s_add_u32 s54, s54, 0x9e3779b9
    s_add_u32 s55, s55, 0x7f4a7c15
    s_add_u32 s56, s56, 0x9e3779b9
    s_add_u32 s57, s57, 0x7f4a7c15
    v_mov_b32 v26, s54
    v_mov_b32 v27, s55
    v_mov_b32 v16, s95
    s_waitcnt vmcnt(8)
    s_barrier
    s_cmp_lg_u32 s48, 0
    s_cbranch_scc1 L_kf
    s_mov_b64 exec, 1
    buffer_store_dwordx2 v[26:27], v16, s[32:35], 0 offen offset:0 sc1
    s_mov_b64 exec, -1
L_kf:
    s_waitcnt vmcnt(6)
    v_perm_b32 v200, v36, v32, s40
    v_perm_b32 v201, v36, v32, s41
    v_perm_b32 v202, v37, v33, s40
    v_perm_b32 v203, v37, v33, s41
    v_perm_b32 v204, v38, v34, s40
    v_perm_b32 v205, v38, v34, s41
    v_perm_b32 v206, v39, v35, s40
    v_perm_b32 v207, v39, v35, s41
    v_dot2_f32_bf16 v224, v200, v40, 0 neg_hi:[0,1,0]
    v_dot2_f32_bf16 v232, v200, v48, 0
    v_dot2_f32_bf16 v225, v201, v41, 0 neg_hi:[0,1,0]
    v_dot2_f32_bf16 v233, v201, v49, 0
    v_dot2_f32_bf16 v226, v202, v42, 0 neg_hi:[0,1,0]
    v_dot2_f32_bf16 v234, v202, v50, 0
    v_dot2_f32_bf16 v227, v203, v43, 0 neg_hi:[0,1,0]
    v_dot2_f32_bf16 v235, v203, v51, 0
    v_dot2_f32_bf16 v228, v204, v44, 0 neg_hi:[0,1,0]
    v_dot2_f32_bf16 v236, v204, v52, 0
    v_dot2_f32_bf16 v229, v205, v45, 0 neg_hi:[0,1,0]
    v_dot2_f32_bf16 v237, v205, v53, 0
    v_dot2_f32_bf16 v230, v206, v46, 0 neg_hi:[0,1,0]
    v_dot2_f32_bf16 v238, v206, v54, 0
    v_dot2_f32_bf16 v231, v207, v47, 0 neg_hi:[0,1,0]
    v_dot2_f32_bf16 v239, v207, v55, 0
    v_cvt_pk_bf16_f32 v152, v224, v225
    v_cvt_pk_bf16_f32 v153, v226, v227
    v_cvt_pk_bf16_f32 v154, v232, v233
    v_cvt_pk_bf16_f32 v155, v234, v235
    v_cvt_pk_bf16_f32 v156, v228, v229
    v_cvt_pk_bf16_f32 v157, v230, v231
    v_cvt_pk_bf16_f32 v158, v236, v237
    v_cvt_pk_bf16_f32 v159, v238, v239
    ds_write_b128 v25, v[152:155] offset:0
    ds_write_b128 v25, v[156:159] offset:512
    s_waitcnt vmcnt(4)
    v_perm_b32 v200, v60, v56, s40
    v_perm_b32 v201, v60, v56, s41
    v_perm_b32 v202, v61, v57, s40
    v_perm_b32 v203, v61, v57, s41
    v_perm_b32 v204, v62, v58, s40
    v_perm_b32 v205, v62, v58, s41
    v_perm_b32 v206, v63, v59, s40
    v_perm_b32 v207, v63, v59, s41
    v_dot2_f32_bf16 v224, v200, v64, 0 neg_hi:[0,1,0]
    v_dot2_f32_bf16 v232, v200, v72, 0
    v_dot2_f32_bf16 v225, v201, v65, 0 neg_hi:[0,1,0]
    v_dot2_f32_bf16 v233, v201, v73, 0
    v_dot2_f32_bf16 v226, v202, v66, 0 neg_hi:[0,1,0]
    v_dot2_f32_bf16 v234, v202, v74, 0
    v_dot2_f32_bf16 v227, v203, v67, 0 neg_hi:[0,1,0]
    v_dot2_f32_bf16 v235, v203, v75, 0
    v_dot2_f32_bf16 v228, v204, v68, 0 neg_hi:[0,1,0]
    v_dot2_f32_bf16 v236, v204, v76, 0
    v_dot2_f32_bf16 v229, v205, v69, 0 neg_hi:[0,1,0]
    v_dot2_f32_bf16 v237, v205, v77, 0
    v_dot2_f32_bf16 v230, v206, v70, 0 neg_hi:[0,1,0]
    v_dot2_f32_bf16 v238, v206, v78, 0
    v_dot2_f32_bf16 v231, v207, v71, 0 neg_hi:[0,1,0]
    v_dot2_f32_bf16 v239, v207, v79, 0
    v_cvt_pk_bf16_f32 v160, v224, v225
    v_cvt_pk_bf16_f32 v161, v226, v227
    v_cvt_pk_bf16_f32 v162, v232, v233
    v_cvt_pk_bf16_f32 v163, v234, v235
    v_cvt_pk_bf16_f32 v164, v228, v229
    v_cvt_pk_bf16_f32 v165, v230, v231
    v_cvt_pk_bf16_f32 v166, v236, v237
    v_cvt_pk_bf16_f32 v167, v238, v239
    ds_write_b128 v25, v[160:163] offset:8320
    ds_write_b128 v25, v[164:167] offset:8832
    s_waitcnt vmcnt(2)
    v_perm_b32 v200, v84, v80, s40
    v_perm_b32 v201, v84, v80, s41
    v_perm_b32 v202, v85, v81, s40
    v_perm_b32 v203, v85, v81, s41
    v_perm_b32 v204, v86, v82, s40
    v_perm_b32 v205, v86, v82, s41
    v_perm_b32 v206, v87, v83, s40
    v_perm_b32 v207, v87, v83, s41
    v_dot2_f32_bf16 v224, v200, v88, 0 neg_hi:[0,1,0]
    v_dot2_f32_bf16 v232, v200, v96, 0
    v_dot2_f32_bf16 v225, v201, v89, 0 neg_hi:[0,1,0]
    v_dot2_f32_bf16 v233, v201, v97, 0
    v_dot2_f32_bf16 v226, v202, v90, 0 neg_hi:[0,1,0]
    v_dot2_f32_bf16 v234, v202, v98, 0
    v_dot2_f32_bf16 v227, v203, v91, 0 neg_hi:[0,1,0]
    v_dot2_f32_bf16 v235, v203, v99, 0
    v_dot2_f32_bf16 v228, v204, v92, 0 neg_hi:[0,1,0]
    v_dot2_f32_bf16 v236, v204, v100, 0
    v_dot2_f32_bf16 v229, v205, v93, 0 neg_hi:[0,1,0]
    v_dot2_f32_bf16 v237, v205, v101, 0
    v_dot2_f32_bf16 v230, v206, v94, 0 neg_hi:[0,1,0]
    v_dot2_f32_bf16 v238, v206, v102, 0
    v_dot2_f32_bf16 v231, v207, v95, 0 neg_hi:[0,1,0]
    v_dot2_f32_bf16 v239, v207, v103, 0
    v_cvt_pk_bf16_f32 v152, v224, v225
    v_cvt_pk_bf16_f32 v153, v226, v227
    v_cvt_pk_bf16_f32 v154, v232, v233
    v_cvt_pk_bf16_f32 v155, v234, v235
    v_cvt_pk_bf16_f32 v156, v228, v229
    v_cvt_pk_bf16_f32 v157, v230, v231
    v_cvt_pk_bf16_f32 v158, v236, v237
    v_cvt_pk_bf16_f32 v159, v238, v239
    ds_write_b128 v25, v[152:155] offset:16640
    ds_write_b128 v25, v[156:159] offset:17152
    s_cmp_lg_u32 s48, 0
    s_cbranch_scc1 L_pk_done
    s_lshl_b32 s89, s52, 11
    s_add_u32 s89, s89, 14680064
    v_lshlrev_b32 v16, 7, v0
    s_mov_b64 exec, 0xffff
L_pk:
    buffer_load_dwordx2 v[26:27], v16, s[32:35], s89 offen offset:0 sc1
    s_add_u32 s88, s88, 1
    s_cmp_gt_u32 s88, 100000
    s_cbranch_scc1 L_pk_out
    s_waitcnt vmcnt(0)
    v_cmp_ne_u64 vcc, s[54:55], v[26:27]
    s_cbranch_vccnz L_pk
L_pk_out:
    s_mov_b64 exec, -1
L_pk_done:
    s_waitcnt lgkmcnt(0)
    s_barrier
    buffer_load_dwordx4 a[0:3], v1, s[32:35], s58 offen sc1
    buffer_load_dwordx4 a[4:7], v1, s[32:35], s58 offen offset:1024 sc1
    buffer_load_dwordx4 a[8:11], v1, s[32:35], s58 offen offset:2048 sc1
    buffer_load_dwordx4 a[12:15], v1, s[32:35], s58 offen offset:3072 sc1
    buffer_load_dwordx4 a[16:19], v1, s[32:35], s59 offen sc1
    buffer_load_dwordx4 a[20:23], v1, s[32:35], s59 offen offset:1024 sc1
    buffer_load_dwordx4 a[24:27], v1, s[32:35], s59 offen offset:2048 sc1
    buffer_load_dwordx4 a[28:31], v1, s[32:35], s59 offen offset:3072 sc1
    buffer_load_dwordx4 a[32:35], v1, s[32:35], s60 offen sc1
    buffer_load_dwordx4 a[36:39], v1, s[32:35], s60 offen offset:1024 sc1
    buffer_load_dwordx4 a[40:43], v1, s[32:35], s60 offen offset:2048 sc1
    buffer_load_dwordx4 a[44:47], v1, s[32:35], s60 offen offset:3072 sc1
    buffer_load_dwordx4 a[48:51], v1, s[32:35], s61 offen sc1
    buffer_load_dwordx4 a[52:55], v1, s[32:35], s61 offen offset:1024 sc1
    buffer_load_dwordx4 a[56:59], v1, s[32:35], s61 offen offset:2048 sc1
    buffer_load_dwordx4 a[60:63], v1, s[32:35], s61 offen offset:3072 sc1
    s_waitcnt vmcnt(16)
    v_perm_b32 v200, v108, v104, s40
    v_perm_b32 v201, v108, v104, s41
    v_perm_b32 v202, v109, v105, s40
    v_perm_b32 v203, v109, v105, s41
    v_perm_b32 v204, v110, v106, s40
    v_perm_b32 v205, v110, v106, s41
    v_perm_b32 v206, v111, v107, s40
    v_perm_b32 v207, v111, v107, s41
    v_dot2_f32_bf16 v224, v200, v112, 0 neg_hi:[0,1,0]
    v_dot2_f32_bf16 v232, v200, v120, 0
    v_dot2_f32_bf16 v225, v201, v113, 0 neg_hi:[0,1,0]
    v_dot2_f32_bf16 v233, v201, v121, 0
    v_dot2_f32_bf16 v226, v202, v114, 0 neg_hi:[0,1,0]
    v_dot2_f32_bf16 v234, v202, v122, 0
    v_dot2_f32_bf16 v227, v203, v115, 0 neg_hi:[0,1,0]
    v_dot2_f32_bf16 v235, v203, v123, 0
    v_dot2_f32_bf16 v228, v204, v116, 0 neg_hi:[0,1,0]
    v_dot2_f32_bf16 v236, v204, v124, 0
    v_dot2_f32_bf16 v229, v205, v117, 0 neg_hi:[0,1,0]
    v_dot2_f32_bf16 v237, v205, v125, 0
    v_dot2_f32_bf16 v230, v206, v118, 0 neg_hi:[0,1,0]
    v_dot2_f32_bf16 v238, v206, v126, 0
    v_dot2_f32_bf16 v231, v207, v119, 0 neg_hi:[0,1,0]
    v_dot2_f32_bf16 v239, v207, v127, 0
    v_cvt_pk_bf16_f32 v160, v224, v225
    v_cvt_pk_bf16_f32 v161, v226, v227
    v_cvt_pk_bf16_f32 v162, v232, v233
    v_cvt_pk_bf16_f32 v163, v234, v235
    v_cvt_pk_bf16_f32 v164, v228, v229
    v_cvt_pk_bf16_f32 v165, v230, v231
    v_cvt_pk_bf16_f32 v166, v236, v237
    v_cvt_pk_bf16_f32 v167, v238, v239
    ds_write_b128 v25, v[160:163] offset:24960
    ds_write_b128 v25, v[164:167] offset:25472
    v_mov_b32 v31, s56
    v_mov_b32 v35, s56
    v_mov_b32 v39, s56
    v_add_u32 v6, 128, v4
    s_mov_b32 s40, 0
    v_mov_b32 v7, 0
    v_and_b32 v26, 15, v0
    v_bfe_u32 v27, v0, 4, 1
    v_cmp_eq_u32 vcc, v26, v27
    v_mov_b32 v26, 0x3f803f80
    s_nop 0
    v_cndmask_b32 v252, 0, v26, vcc
    v_cndmask_b32 v253, 0, v26, vcc
    v_cndmask_b32 v254, 0, v26, vcc
    v_cndmask_b32 v255, 0, v26, vcc
    buffer_load_dwordx4 a[128:131], v1, s[32:35], s66 offen sc1
    buffer_load_dwordx4 a[132:135], v1, s[32:35], s66 offen offset:1024 sc1
    buffer_load_dwordx4 a[136:139], v1, s[32:35], s66 offen offset:2048 sc1
    buffer_load_dwordx4 a[140:143], v1, s[32:35], s66 offen offset:3072 sc1
    buffer_load_dwordx4 a[144:147], v1, s[32:35], s67 offen sc1
    buffer_load_dwordx4 a[148:151], v1, s[32:35], s67 offen offset:1024 sc1
    buffer_load_dwordx4 a[152:155], v1, s[32:35], s67 offen offset:2048 sc1
    buffer_load_dwordx4 a[156:159], v1, s[32:35], s67 offen offset:3072 sc1
    ds_read_b128 v[160:163], v1 offset:0
    ds_read_b128 v[164:167], v1 offset:1040
    ds_read_b128 v[168:171], v1 offset:2080
    ds_read_b128 v[172:175], v1 offset:3120
    ds_read_b128 v[176:179], v1 offset:4160
    ds_read_b128 v[180:183], v1 offset:5200
    ds_read_b128 v[184:187], v1 offset:6240
    ds_read_b128 v[188:191], v1 offset:7280
    s_or_b32 s89, s51, s48
    s_cmp_lg_u32 s89, 0
    s_cbranch_scc1 L_noxk
    v_mov_b32 v26, s54
    v_mov_b32 v27, s55
    v_mov_b32 v16, s93
    s_mov_b64 exec, 1
    buffer_store_dwordx2 v[26:27], v16, s[32:35], 0 offen sc1
    s_mov_b64 exec, -1
L_noxk:
    s_waitcnt vmcnt(23) lgkmcnt(7)
    v_mfma_f32_32x32x16_bf16 v[48:63], a[0:3], v[160:163], 0
    s_waitcnt vmcnt(22) lgkmcnt(6)
    ds_read_b128 v[192:195], v1 offset:8320
    ds_read_b128 v[196:199], v1 offset:9360
    buffer_load_dwordx4 a[64:67], v1, s[32:35], s62 offen sc1
    v_mfma_f32_32x32x16_bf16 v[48:63], a[4:7], v[164:167], v[48:63]
    s_waitcnt vmcnt(22) lgkmcnt(7)
    ds_read_b128 v[200:203], v1 offset:10400
    ds_read_b128 v[204:207], v1 offset:11440
    v_mfma_f32_32x32x16_bf16 v[48:63], a[8:11], v[168:171], v[48:63]
    s_waitcnt vmcnt(21) lgkmcnt(8)
    ds_read_b128 v[208:211], v1 offset:12480
    ds_read_b128 v[212:215], v1 offset:13520
    buffer_load_dwordx4 a[68:71], v1, s[32:35], s62 offen offset:1024 sc1
    v_mfma_f32_32x32x16_bf16 v[48:63], a[12:15], v[172:175], v[48:63]
    s_waitcnt vmcnt(21) lgkmcnt(9)
    ds_read_b128 v[216:219], v1 offset:14560
    ds_read_b128 v[220:223], v1 offset:15600
    v_mfma_f32_32x32x16_bf16 v[48:63], a[16:19], v[176:179], v[48:63]
    s_waitcnt vmcnt(20) lgkmcnt(10)
    buffer_load_dwordx4 a[72:75], v1, s[32:35], s62 offen offset:2048 sc1
    v_mfma_f32_32x32x16_bf16 v[48:63], a[20:23], v[180:183], v[48:63]
    s_waitcnt vmcnt(20) lgkmcnt(9)
    v_mfma_f32_32x32x16_bf16 v[48:63], a[24:27], v[184:187], v[48:63]
    s_waitcnt vmcnt(19) lgkmcnt(8)
    buffer_load_dwordx4 a[76:79], v1, s[32:35], s62 offen offset:3072 sc1
    v_mfma_f32_32x32x16_bf16 v[48:63], a[28:31], v[188:191], v[48:63]
    s_waitcnt lgkmcnt(7)
    v_mfma_f32_32x32x16_bf16 v[64:79], a[0:3], v[192:195], 0
    s_waitcnt lgkmcnt(6)
    buffer_load_dwordx4 a[80:83], v1, s[32:35], s63 offen sc1
    v_mfma_f32_32x32x16_bf16 v[64:79], a[4:7], v[196:199], v[64:79]
    s_waitcnt lgkmcnt(5)
    v_exp_f32 v48, v48
    v_exp_f32 v49, v49
    v_exp_f32 v50, v50
    v_mfma_f32_32x32x16_bf16 v[64:79], a[8:11], v[200:203], v[64:79]
    s_waitcnt lgkmcnt(4)
    v_exp_f32 v51, v51
    v_exp_f32 v52, v52
    v_exp_f32 v53, v53
    v_mfma_f32_32x32x16_bf16 v[64:79], a[12:15], v[204:207], v[64:79]
    s_waitcnt lgkmcnt(3)
    v_exp_f32 v54, v54
    v_exp_f32 v55, v55
    v_exp_f32 v56, v56
    v_mfma_f32_32x32x16_bf16 v[64:79], a[16:19], v[208:211], v[64:79]
    s_waitcnt lgkmcnt(2)
    v_exp_f32 v57, v57
    v_exp_f32 v58, v58
    v_exp_f32 v59, v59
    v_mfma_f32_32x32x16_bf16 v[64:79], a[20:23], v[212:215], v[64:79]
    s_waitcnt lgkmcnt(1)
    v_exp_f32 v60, v60
    v_exp_f32 v61, v61
    v_exp_f32 v62, v62
    v_mfma_f32_32x32x16_bf16 v[64:79], a[24:27], v[216:219], v[64:79]
    s_waitcnt lgkmcnt(0)
    v_exp_f32 v63, v63
    v_cvt_pk_bf16_f32 v20, v48, v49
    v_cvt_pk_bf16_f32 v21, v50, v51
    v_cvt_pk_bf16_f32 v22, v52, v53
    v_mfma_f32_32x32x16_bf16 v[64:79], a[28:31], v[220:223], v[64:79]
    s_waitcnt vmcnt(20)
    v_cvt_pk_bf16_f32 v23, v54, v55
    v_cvt_pk_bf16_f32 v24, v56, v57
    v_cvt_pk_bf16_f32 v25, v58, v59
    v_cvt_pk_bf16_f32 v26, v60, v61
    v_cvt_pk_bf16_f32 v27, v62, v63
    v_mfma_f32_32x32x16_bf16 v[224:239], a[32:35], v[160:163], 0
    ds_write_b128 v2, v[20:23] offset:0
    v_mfma_f32_16x16x32_bf16 v[40:43], v[252:255], v[20:23], 0
    s_waitcnt vmcnt(19)
    v_mfma_f32_32x32x16_bf16 v[224:239], a[36:39], v[164:167], v[224:239]
    ds_write_b128 v2, v[24:27] offset:1024
    v_mfma_f32_16x16x32_bf16 v[40:43], v[252:255], v[24:27], v[40:43]
    s_waitcnt vmcnt(18)
    v_mfma_f32_32x32x16_bf16 v[224:239], a[40:43], v[168:171], v[224:239]
    s_waitcnt vmcnt(17)
    buffer_load_dwordx4 a[84:87], v1, s[32:35], s63 offen offset:1024 sc1
    v_exp_f32 v64, v64
    v_exp_f32 v65, v65
    v_mfma_f32_32x32x16_bf16 v[224:239], a[44:47], v[172:175], v[224:239]
    s_waitcnt vmcnt(17) lgkmcnt(0)
    s_barrier
    v_mfma_f32_32x32x16_bf16 v[224:239], a[48:51], v[176:179], v[224:239]
    s_waitcnt vmcnt(16)
    ds_read_b128 v[128:131], v1 offset:33280
    ds_read_b128 v[132:135], v1 offset:34304
    buffer_load_dwordx4 a[88:91], v1, s[32:35], s63 offen offset:2048 sc1
    v_exp_f32 v66, v66
    v_mfma_f32_32x32x16_bf16 v[224:239], a[52:55], v[180:183], v[224:239]
    s_waitcnt vmcnt(16)
    ds_read_b128 v[136:139], v1 offset:35328
    ds_read_b128 v[140:143], v1 offset:36352
    buffer_load_dwordx4 a[92:95], v1, s[32:35], s63 offen offset:3072 sc1
    v_exp_f32 v67, v67
    v_mfma_f32_32x32x16_bf16 v[224:239], a[56:59], v[184:187], v[224:239]
    s_waitcnt vmcnt(16)
    ds_read_b128 v[144:147], v1 offset:37376
    ds_read_b128 v[148:151], v1 offset:38400
    v_exp_f32 v68, v68
    v_exp_f32 v69, v69
    v_mfma_f32_32x32x16_bf16 v[224:239], a[60:63], v[188:191], v[224:239]
    s_waitcnt vmcnt(15) lgkmcnt(5)
    ds_read_b128 v[152:155], v1 offset:39424
    ds_read_b128 v[156:159], v1 offset:40448
    v_exp_f32 v70, v70
    v_exp_f32 v71, v71
    v_mfma_f32_32x32x16_bf16 v[80:95], a[128:131], v[128:131], 0
    s_waitcnt vmcnt(14) lgkmcnt(6)
    v_exp_f32 v72, v72
    v_exp_f32 v73, v73
    v_exp_f32 v74, v74
    v_mfma_f32_32x32x16_bf16 v[80:95], a[132:135], v[132:135], v[80:95]
    s_waitcnt vmcnt(13) lgkmcnt(5)
    v_exp_f32 v75, v75
    v_exp_f32 v76, v76
    v_exp_f32 v77, v77
    v_mfma_f32_32x32x16_bf16 v[80:95], a[136:139], v[136:139], v[80:95]
    s_waitcnt vmcnt(12) lgkmcnt(4)
    buffer_load_dwordx4 a[160:163], v1, s[32:35], s68 offen sc1
    v_exp_f32 v78, v78
    v_exp_f32 v79, v79
    v_mfma_f32_32x32x16_bf16 v[80:95], a[140:143], v[140:143], v[80:95]
    s_waitcnt vmcnt(12) lgkmcnt(3)
    buffer_load_dwordx4 a[164:167], v1, s[32:35], s68 offen offset:1024 sc1
    v_cvt_pk_bf16_f32 v20, v64, v65
    v_cvt_pk_bf16_f32 v21, v66, v67
    v_cvt_pk_bf16_f32 v22, v68, v69
    v_mfma_f32_32x32x16_bf16 v[80:95], a[144:147], v[144:147], v[80:95]
    s_waitcnt vmcnt(12) lgkmcnt(2)
    buffer_load_dwordx4 a[168:171], v1, s[32:35], s68 offen offset:2048 sc1
    v_cvt_pk_bf16_f32 v23, v70, v71
    v_cvt_pk_bf16_f32 v24, v72, v73
    v_cvt_pk_bf16_f32 v25, v74, v75
    v_mfma_f32_32x32x16_bf16 v[80:95], a[148:151], v[148:151], v[80:95]
    ds_write_b128 v2, v[20:23] offset:8192
    v_mfma_f32_16x16x32_bf16 v[44:47], v[252:255], v[20:23], 0
    s_waitcnt vmcnt(12) lgkmcnt(2)
    v_mfma_f32_32x32x16_bf16 v[80:95], a[152:155], v[152:155], v[80:95]
    s_waitcnt vmcnt(11) lgkmcnt(1)
    buffer_load_dwordx4 a[172:175], v1, s[32:35], s68 offen offset:3072 sc1
    v_cvt_pk_bf16_f32 v26, v76, v77
    v_cvt_pk_bf16_f32 v27, v78, v79
    v_mfma_f32_32x32x16_bf16 v[80:95], a[156:159], v[156:159], v[80:95]
    ds_write_b128 v2, v[24:27] offset:9216
    v_mfma_f32_16x16x32_bf16 v[44:47], v[252:255], v[24:27], v[44:47]
    v_mfma_f32_32x32x16_bf16 v[48:63], a[32:35], v[192:195], 0
    v_exp_f32 v224, v224
    v_exp_f32 v225, v225
    v_exp_f32 v226, v226
    v_mfma_f32_32x32x16_bf16 v[48:63], a[36:39], v[196:199], v[48:63]
    s_waitcnt lgkmcnt(0)
    s_barrier
    v_mfma_f32_32x32x16_bf16 v[48:63], a[40:43], v[200:203], v[48:63]
    ds_read_b128 v[128:131], v1 offset:41472
    ds_read_b128 v[132:135], v1 offset:42496
    v_exp_f32 v227, v227
    v_exp_f32 v228, v228
    v_mfma_f32_32x32x16_bf16 v[48:63], a[44:47], v[204:207], v[48:63]
    ds_read_b128 v[136:139], v1 offset:43520
    ds_read_b128 v[140:143], v1 offset:44544
    v_exp_f32 v229, v229
    v_exp_f32 v230, v230
    v_mfma_f32_32x32x16_bf16 v[48:63], a[48:51], v[208:211], v[48:63]
    ds_read_b128 v[144:147], v1 offset:45568
    v_exp_f32 v231, v231
    v_exp_f32 v232, v232
    v_mfma_f32_32x32x16_bf16 v[48:63], a[52:55], v[212:215], v[48:63]
    ds_read_b128 v[148:151], v1 offset:46592
    v_exp_f32 v233, v233
    v_exp_f32 v234, v234
    v_mfma_f32_32x32x16_bf16 v[48:63], a[56:59], v[216:219], v[48:63]
    ds_read_b128 v[152:155], v1 offset:47616
    v_exp_f32 v235, v235
    v_exp_f32 v236, v236
    v_mfma_f32_32x32x16_bf16 v[48:63], a[60:63], v[220:223], v[48:63]
    s_waitcnt lgkmcnt(6)
    ds_read_b128 v[156:159], v1 offset:48640
    v_exp_f32 v237, v237
    v_exp_f32 v238, v238
    v_mfma_f32_32x32x16_bf16 v[96:111], a[128:131], v[128:131], 0
    s_waitcnt lgkmcnt(6)
    buffer_load_dwordx4 a[176:179], v1, s[32:35], s69 offen sc1
    v_exp_f32 v239, v239
    v_cvt_pk_bf16_f32 v20, v224, v225
    v_mfma_f32_32x32x16_bf16 v[96:111], a[132:135], v[132:135], v[96:111]
    s_waitcnt lgkmcnt(5)
    buffer_load_dwordx4 a[180:183], v1, s[32:35], s69 offen offset:1024 sc1
    v_cvt_pk_bf16_f32 v21, v226, v227
    v_cvt_pk_bf16_f32 v22, v228, v229
    v_cvt_pk_bf16_f32 v23, v230, v231
    v_mfma_f32_32x32x16_bf16 v[96:111], a[136:139], v[136:139], v[96:111]
    ds_write_b128 v2, v[20:23] offset:0
    v_mfma_f32_16x16x32_bf16 v[40:43], v[252:255], v[20:23], v[40:43]
    s_waitcnt lgkmcnt(5)
    v_mfma_f32_32x32x16_bf16 v[96:111], a[140:143], v[140:143], v[96:111]
    s_waitcnt lgkmcnt(4)
    buffer_load_dwordx4 a[184:187], v1, s[32:35], s69 offen offset:2048 sc1
    v_cvt_pk_bf16_f32 v24, v232, v233
    v_cvt_pk_bf16_f32 v25, v234, v235
    v_cvt_pk_bf16_f32 v26, v236, v237
    v_mfma_f32_32x32x16_bf16 v[96:111], a[144:147], v[144:147], v[96:111]
    s_waitcnt lgkmcnt(3)
    buffer_load_dwordx4 a[188:191], v1, s[32:35], s69 offen offset:3072 sc1
    v_exp_f32 v48, v48
    v_cvt_pk_bf16_f32 v27, v238, v239
    v_mfma_f32_32x32x16_bf16 v[96:111], a[148:151], v[148:151], v[96:111]
    ds_write_b128 v2, v[24:27] offset:1024
    v_mfma_f32_16x16x32_bf16 v[40:43], v[252:255], v[24:27], v[40:43]
    s_waitcnt lgkmcnt(3)
    v_mfma_f32_32x32x16_bf16 v[96:111], a[152:155], v[152:155], v[96:111]
    s_waitcnt lgkmcnt(2)
    buffer_load_dwordx4 a[96:99], v1, s[32:35], s64 offen sc1
    v_exp_f32 v49, v49
    v_exp_f32 v50, v50
    v_mfma_f32_32x32x16_bf16 v[96:111], a[156:159], v[156:159], v[96:111]
    s_waitcnt vmcnt(16) lgkmcnt(0)
    s_barrier
    v_mfma_f32_32x32x16_bf16 v[64:79], a[64:67], v[160:163], 0
    s_waitcnt vmcnt(15)
    ds_read_b128 v[128:131], v1 offset:33280
    buffer_load_dwordx4 a[100:103], v1, s[32:35], s64 offen offset:1024 sc1
    v_exp_f32 v51, v51
    v_mfma_f32_32x32x16_bf16 v[64:79], a[68:71], v[164:167], v[64:79]
    s_waitcnt vmcnt(15)
    ds_read_b128 v[132:135], v1 offset:34304
    buffer_load_dwordx4 a[104:107], v1, s[32:35], s64 offen offset:2048 sc1
    v_exp_f32 v52, v52
    v_mfma_f32_32x32x16_bf16 v[64:79], a[72:75], v[168:171], v[64:79]
    s_waitcnt vmcnt(15)
    ds_read_b128 v[136:139], v1 offset:35328
    buffer_load_dwordx4 a[108:111], v1, s[32:35], s64 offen offset:3072 sc1
    v_exp_f32 v53, v53
    v_mfma_f32_32x32x16_bf16 v[64:79], a[76:79], v[172:175], v[64:79]
    s_waitcnt vmcnt(15)
    ds_read_b128 v[140:143], v1 offset:36352
    v_exp_f32 v54, v54
    v_exp_f32 v55, v55
    v_mfma_f32_32x32x16_bf16 v[64:79], a[80:83], v[176:179], v[64:79]
    s_waitcnt vmcnt(14)
    ds_read_b128 v[144:147], v1 offset:37376
    v_exp_f32 v56, v56
    v_exp_f32 v57, v57
    v_mfma_f32_32x32x16_bf16 v[64:79], a[84:87], v[180:183], v[64:79]
    s_waitcnt vmcnt(13)
    ds_read_b128 v[148:151], v1 offset:38400
    v_exp_f32 v58, v58
    v_exp_f32 v59, v59
    v_mfma_f32_32x32x16_bf16 v[64:79], a[88:91], v[184:187], v[64:79]
    s_waitcnt vmcnt(12)
    ds_read_b128 v[152:155], v1 offset:39424
    v_exp_f32 v60, v60
    v_exp_f32 v61, v61
    v_mfma_f32_32x32x16_bf16 v[64:79], a[92:95], v[188:191], v[64:79]
    s_waitcnt vmcnt(11) lgkmcnt(6)
    ds_read_b128 v[156:159], v1 offset:40448
    v_exp_f32 v62, v62
    v_exp_f32 v63, v63
    v_mfma_f32_32x32x16_bf16 v[80:95], a[160:163], v[128:131], v[80:95]
    s_waitcnt vmcnt(10) lgkmcnt(6)
    buffer_load_dwordx4 a[112:115], v1, s[32:35], s65 offen sc1
    v_cvt_pk_bf16_f32 v20, v48, v49
    v_cvt_pk_bf16_f32 v21, v50, v51
    v_cvt_pk_bf16_f32 v22, v52, v53
    v_mfma_f32_32x32x16_bf16 v[80:95], a[164:167], v[132:135], v[80:95]
    s_waitcnt vmcnt(10) lgkmcnt(5)
    buffer_load_dwordx4 a[116:119], v1, s[32:35], s65 offen offset:1024 sc1
    v_cvt_pk_bf16_f32 v23, v54, v55
    v_cvt_pk_bf16_f32 v24, v56, v57
    v_cvt_pk_bf16_f32 v25, v58, v59
    v_mfma_f32_32x32x16_bf16 v[80:95], a[168:171], v[136:139], v[80:95]
    ds_write_b128 v2, v[20:23] offset:8192
    v_mfma_f32_16x16x32_bf16 v[44:47], v[252:255], v[20:23], v[44:47]
    s_waitcnt vmcnt(10) lgkmcnt(5)
    v_mfma_f32_32x32x16_bf16 v[80:95], a[172:175], v[140:143], v[80:95]
    s_waitcnt vmcnt(9) lgkmcnt(4)
    buffer_load_dwordx4 a[120:123], v1, s[32:35], s65 offen offset:2048 sc1
    v_cvt_pk_bf16_f32 v26, v60, v61
    v_cvt_pk_bf16_f32 v27, v62, v63
    v_mfma_f32_32x32x16_bf16 v[80:95], a[176:179], v[144:147], v[80:95]
    ds_write_b128 v2, v[24:27] offset:9216
    v_mfma_f32_16x16x32_bf16 v[44:47], v[252:255], v[24:27], v[44:47]
    s_waitcnt vmcnt(9) lgkmcnt(4)
    v_mfma_f32_32x32x16_bf16 v[80:95], a[180:183], v[148:151], v[80:95]
    s_waitcnt vmcnt(8) lgkmcnt(3)
    buffer_load_dwordx4 a[124:127], v1, s[32:35], s65 offen offset:3072 sc1
    v_exp_f32 v64, v64
    v_exp_f32 v65, v65
    v_mfma_f32_32x32x16_bf16 v[80:95], a[184:187], v[152:155], v[80:95]
    s_waitcnt vmcnt(8) lgkmcnt(2)
    buffer_load_dwordx4 a[192:195], v1, s[32:35], s70 offen sc1
    v_exp_f32 v66, v66
    v_exp_f32 v67, v67
    v_mfma_f32_32x32x16_bf16 v[80:95], a[188:191], v[156:159], v[80:95]
    s_waitcnt lgkmcnt(0)
    s_barrier
    v_mfma_f32_32x32x16_bf16 v[48:63], a[64:67], v[192:195], 0
    ds_read_b128 v[128:131], v1 offset:41472
    buffer_load_dwordx4 a[196:199], v1, s[32:35], s70 offen offset:1024 sc1
    v_exp_f32 v68, v68
    v_mfma_f32_32x32x16_bf16 v[48:63], a[68:71], v[196:199], v[48:63]
    ds_read_b128 v[132:135], v1 offset:42496
    buffer_load_dwordx4 a[200:203], v1, s[32:35], s70 offen offset:2048 sc1
    v_exp_f32 v69, v69
    v_mfma_f32_32x32x16_bf16 v[48:63], a[72:75], v[200:203], v[48:63]
    ds_read_b128 v[136:139], v1 offset:43520
    buffer_load_dwordx4 a[204:207], v1, s[32:35], s70 offen offset:3072 sc1
    v_exp_f32 v70, v70
    v_mfma_f32_32x32x16_bf16 v[48:63], a[76:79], v[204:207], v[48:63]
    ds_read_b128 v[140:143], v1 offset:44544
    v_exp_f32 v71, v71
    v_exp_f32 v72, v72
    v_mfma_f32_32x32x16_bf16 v[48:63], a[80:83], v[208:211], v[48:63]
    ds_read_b128 v[144:147], v1 offset:45568
    v_exp_f32 v73, v73
    v_exp_f32 v74, v74
    v_mfma_f32_32x32x16_bf16 v[48:63], a[84:87], v[212:215], v[48:63]
    ds_read_b128 v[148:151], v1 offset:46592
    v_exp_f32 v75, v75
    v_exp_f32 v76, v76
    v_mfma_f32_32x32x16_bf16 v[48:63], a[88:91], v[216:219], v[48:63]
    ds_read_b128 v[152:155], v1 offset:47616
    v_exp_f32 v77, v77
    v_exp_f32 v78, v78
    v_mfma_f32_32x32x16_bf16 v[48:63], a[92:95], v[220:223], v[48:63]
    s_waitcnt lgkmcnt(6)
    ds_read_b128 v[156:159], v1 offset:48640
    buffer_load_dwordx4 a[208:211], v1, s[32:35], s71 offen sc1
    v_exp_f32 v79, v79
    v_mfma_f32_32x32x16_bf16 v[96:111], a[160:163], v[128:131], v[96:111]
    s_waitcnt lgkmcnt(6)
    buffer_load_dwordx4 a[212:215], v1, s[32:35], s71 offen offset:1024 sc1
    v_cvt_pk_bf16_f32 v20, v64, v65
    v_cvt_pk_bf16_f32 v21, v66, v67
    v_cvt_pk_bf16_f32 v22, v68, v69
    v_mfma_f32_32x32x16_bf16 v[96:111], a[164:167], v[132:135], v[96:111]
    s_waitcnt lgkmcnt(5)
    buffer_load_dwordx4 a[216:219], v1, s[32:35], s71 offen offset:2048 sc1
    v_cvt_pk_bf16_f32 v23, v70, v71
    v_cvt_pk_bf16_f32 v24, v72, v73
    v_cvt_pk_bf16_f32 v25, v74, v75
    v_mfma_f32_32x32x16_bf16 v[96:111], a[168:171], v[136:139], v[96:111]
    ds_write_b128 v2, v[20:23] offset:0
    v_mfma_f32_16x16x32_bf16 v[40:43], v[252:255], v[20:23], v[40:43]
    s_waitcnt lgkmcnt(5)
    v_mfma_f32_32x32x16_bf16 v[96:111], a[172:175], v[140:143], v[96:111]
    s_waitcnt lgkmcnt(4)
    buffer_load_dwordx4 a[220:223], v1, s[32:35], s71 offen offset:3072 sc1
    v_cvt_pk_bf16_f32 v26, v76, v77
    v_cvt_pk_bf16_f32 v27, v78, v79
    v_mfma_f32_32x32x16_bf16 v[96:111], a[176:179], v[144:147], v[96:111]
    ds_write_b128 v2, v[24:27] offset:1024
    v_mfma_f32_16x16x32_bf16 v[40:43], v[252:255], v[24:27], v[40:43]
    s_waitcnt lgkmcnt(4)
    v_mfma_f32_32x32x16_bf16 v[96:111], a[180:183], v[148:151], v[96:111]
    s_waitcnt lgkmcnt(3)
    buffer_load_dwordx4 a[224:227], v1, s[32:35], s72 offen sc1
    v_exp_f32 v48, v48
    v_exp_f32 v49, v49
    v_mfma_f32_32x32x16_bf16 v[96:111], a[184:187], v[152:155], v[96:111]
    s_waitcnt lgkmcnt(2)
    buffer_load_dwordx4 a[228:231], v1, s[32:35], s72 offen offset:1024 sc1
    v_exp_f32 v50, v50
    v_exp_f32 v51, v51
    v_mfma_f32_32x32x16_bf16 v[96:111], a[188:191], v[156:159], v[96:111]
    s_waitcnt vmcnt(17) lgkmcnt(0)
    s_barrier
    v_mfma_f32_32x32x16_bf16 v[64:79], a[96:99], v[160:163], 0
    s_waitcnt vmcnt(16)
    ds_read_b128 v[128:131], v1 offset:33280
    buffer_load_dwordx4 a[232:235], v1, s[32:35], s72 offen offset:2048 sc1
    v_exp_f32 v52, v52
    v_mfma_f32_32x32x16_bf16 v[64:79], a[100:103], v[164:167], v[64:79]
    s_waitcnt vmcnt(16)
    ds_read_b128 v[132:135], v1 offset:34304
    buffer_load_dwordx4 a[236:239], v1, s[32:35], s72 offen offset:3072 sc1
    ds_read_b128 v[160:163], v1 offset:16640
    v_exp_f32 v53, v53
    v_mfma_f32_32x32x16_bf16 v[64:79], a[104:107], v[168:171], v[64:79]
    s_waitcnt vmcnt(16)
    ds_read_b128 v[136:139], v1 offset:35328
    ds_read_b128 v[164:167], v1 offset:17680
    v_exp_f32 v54, v54
    v_exp_f32 v55, v55
    v_mfma_f32_32x32x16_bf16 v[64:79], a[108:111], v[172:175], v[64:79]
    s_waitcnt vmcnt(15)
    ds_read_b128 v[140:143], v1 offset:36352
    ds_read_b128 v[168:171], v1 offset:18720
    v_exp_f32 v56, v56
    v_exp_f32 v57, v57
    v_mfma_f32_32x32x16_bf16 v[64:79], a[112:115], v[176:179], v[64:79]
    s_waitcnt vmcnt(14)
    ds_read_b128 v[144:147], v1 offset:37376
    ds_read_b128 v[172:175], v1 offset:19760
    v_exp_f32 v58, v58
    v_exp_f32 v59, v59
    v_mfma_f32_32x32x16_bf16 v[64:79], a[116:119], v[180:183], v[64:79]
    s_waitcnt vmcnt(13)
    ds_read_b128 v[148:151], v1 offset:38400
    ds_read_b128 v[176:179], v1 offset:20800
    v_exp_f32 v60, v60
    v_exp_f32 v61, v61
    v_mfma_f32_32x32x16_bf16 v[64:79], a[120:123], v[184:187], v[64:79]
    s_waitcnt vmcnt(12)
    ds_read_b128 v[152:155], v1 offset:39424
    ds_read_b128 v[180:183], v1 offset:21840
    v_exp_f32 v62, v62
    v_exp_f32 v63, v63
    v_mfma_f32_32x32x16_bf16 v[64:79], a[124:127], v[188:191], v[64:79]
    s_waitcnt vmcnt(11) lgkmcnt(12)
    ds_read_b128 v[156:159], v1 offset:40448
    buffer_load_dwordx4 a[240:243], v1, s[32:35], s73 offen sc1
    v_cvt_pk_bf16_f32 v20, v48, v49
    v_cvt_pk_bf16_f32 v21, v50, v51
    v_mfma_f32_32x32x16_bf16 v[80:95], a[192:195], v[128:131], v[80:95]
    s_waitcnt vmcnt(11) lgkmcnt(12)
    buffer_load_dwordx4 a[244:247], v1, s[32:35], s73 offen offset:1024 sc1
    v_cvt_pk_bf16_f32 v22, v52, v53
    v_cvt_pk_bf16_f32 v23, v54, v55
    v_cvt_pk_bf16_f32 v24, v56, v57
    v_mfma_f32_32x32x16_bf16 v[80:95], a[196:199], v[132:135], v[80:95]
    ds_write_b128 v2, v[20:23] offset:8192
    v_mfma_f32_16x16x32_bf16 v[44:47], v[252:255], v[20:23], v[44:47]
    s_waitcnt vmcnt(11) lgkmcnt(11)
    v_mfma_f32_32x32x16_bf16 v[80:95], a[200:203], v[136:139], v[80:95]
    s_waitcnt vmcnt(10) lgkmcnt(9)
    buffer_load_dwordx4 a[248:251], v1, s[32:35], s73 offen offset:2048 sc1
    v_cvt_pk_bf16_f32 v25, v58, v59
    v_cvt_pk_bf16_f32 v26, v60, v61
    v_cvt_pk_bf16_f32 v27, v62, v63
    v_mfma_f32_32x32x16_bf16 v[80:95], a[204:207], v[140:143], v[80:95]
    ds_write_b128 v2, v[24:27] offset:9216
    v_mfma_f32_16x16x32_bf16 v[44:47], v[252:255], v[24:27], v[44:47]
    s_waitcnt vmcnt(10) lgkmcnt(8)
    v_mfma_f32_32x32x16_bf16 v[80:95], a[208:211], v[144:147], v[80:95]
    s_waitcnt vmcnt(9) lgkmcnt(6)
    buffer_load_dwordx4 a[252:255], v1, s[32:35], s73 offen offset:3072 sc1
    v_exp_f32 v64, v64
    v_exp_f32 v65, v65
    v_mfma_f32_32x32x16_bf16 v[80:95], a[212:215], v[148:151], v[80:95]
    s_waitcnt vmcnt(9) lgkmcnt(4)
    v_exp_f32 v66, v66
    v_exp_f32 v67, v67
    v_exp_f32 v68, v68
    v_mfma_f32_32x32x16_bf16 v[80:95], a[216:219], v[152:155], v[80:95]
    s_waitcnt vmcnt(8) lgkmcnt(2)
    v_exp_f32 v69, v69
    v_exp_f32 v70, v70
    v_exp_f32 v71, v71
    v_mfma_f32_32x32x16_bf16 v[80:95], a[220:223], v[156:159], v[80:95]
    s_waitcnt lgkmcnt(0)
    ds_read_b128 v[184:187], v1 offset:22880
    s_barrier
    v_mfma_f32_32x32x16_bf16 v[48:63], a[96:99], v[192:195], 0
    ds_read_b128 v[128:131], v1 offset:41472
    ds_read_b128 v[188:191], v1 offset:23920
    v_exp_f32 v72, v72
    v_exp_f32 v73, v73
    v_mfma_f32_32x32x16_bf16 v[48:63], a[100:103], v[196:199], v[48:63]
    ds_read_b128 v[132:135], v1 offset:42496
    ds_read_b128 v[192:195], v1 offset:24960
    v_exp_f32 v74, v74
    v_exp_f32 v75, v75
    v_mfma_f32_32x32x16_bf16 v[48:63], a[104:107], v[200:203], v[48:63]
    ds_read_b128 v[136:139], v1 offset:43520
    ds_read_b128 v[196:199], v1 offset:26000
    v_exp_f32 v76, v76
    v_exp_f32 v77, v77
    v_mfma_f32_32x32x16_bf16 v[48:63], a[108:111], v[204:207], v[48:63]
    ds_read_b128 v[140:143], v1 offset:44544
    ds_read_b128 v[200:203], v1 offset:27040
    v_exp_f32 v78, v78
    v_exp_f32 v79, v79
    v_mfma_f32_32x32x16_bf16 v[48:63], a[112:115], v[208:211], v[48:63]
    ds_read_b128 v[144:147], v1 offset:45568
    v_cvt_pk_bf16_f32 v20, v64, v65
    v_cvt_pk_bf16_f32 v21, v66, v67
    v_cvt_pk_bf16_f32 v22, v68, v69
    v_cvt_pk_bf16_f32 v23, v70, v71
    v_mfma_f32_32x32x16_bf16 v[48:63], a[116:119], v[212:215], v[48:63]
    ds_read_b128 v[148:151], v1 offset:46592
    v_cvt_pk_bf16_f32 v24, v72, v73
    v_cvt_pk_bf16_f32 v25, v74, v75
    v_cvt_pk_bf16_f32 v26, v76, v77
    v_cvt_pk_bf16_f32 v27, v78, v79
    v_mfma_f32_16x16x32_bf16 v[40:43], v[252:255], v[20:23], v[40:43]
    v_mfma_f32_32x32x16_bf16 v[48:63], a[120:123], v[216:219], v[48:63]
    ds_read_b128 v[152:155], v1 offset:47616
    ds_read_b128 v[204:207], v1 offset:28080
    v_mfma_f32_16x16x32_bf16 v[40:43], v[252:255], v[24:27], v[40:43]
    v_mfma_f32_32x32x16_bf16 v[48:63], a[124:127], v[220:223], v[48:63]
    s_waitcnt lgkmcnt(11)
    ds_read_b128 v[156:159], v1 offset:48640
    ds_read_b128 v[208:211], v1 offset:29120
    v_mfma_f32_32x32x16_bf16 v[96:111], a[192:195], v[128:131], v[96:111]
    s_waitcnt lgkmcnt(11)
    ds_write_b128 v2, v[20:23] offset:0
    v_mfma_f32_32x32x16_bf16 v[96:111], a[196:199], v[132:135], v[96:111]
    s_waitcnt lgkmcnt(10)
    ds_read_b128 v[212:215], v1 offset:30160
    ds_read_b128 v[216:219], v1 offset:31200
    ds_write_b32 v3, v40 offset:0
    ds_write_b32 v3, v41 offset:64
    v_mfma_f32_32x32x16_bf16 v[96:111], a[200:203], v[136:139], v[96:111]
    s_waitcnt lgkmcnt(12)
    ds_write_b128 v2, v[24:27] offset:1024
    v_mfma_f32_32x32x16_bf16 v[96:111], a[204:207], v[140:143], v[96:111]
    s_waitcnt lgkmcnt(11)
    v_exp_f32 v48, v48
    v_exp_f32 v49, v49
    v_exp_f32 v50, v50
    v_mfma_f32_32x32x16_bf16 v[96:111], a[208:211], v[144:147], v[96:111]
    s_waitcnt lgkmcnt(10)
    v_exp_f32 v51, v51
    v_exp_f32 v52, v52
    v_exp_f32 v53, v53
    v_mfma_f32_32x32x16_bf16 v[96:111], a[212:215], v[148:151], v[96:111]
    s_waitcnt lgkmcnt(9)
    v_exp_f32 v54, v54
    v_exp_f32 v55, v55
    v_exp_f32 v56, v56
    v_mfma_f32_32x32x16_bf16 v[96:111], a[216:219], v[152:155], v[96:111]
    s_waitcnt lgkmcnt(7)
    v_exp_f32 v57, v57
    v_exp_f32 v58, v58
    v_exp_f32 v59, v59
    v_mfma_f32_32x32x16_bf16 v[96:111], a[220:223], v[156:159], v[96:111]
    s_waitcnt lgkmcnt(0)
    ds_read_b128 v[220:223], v1 offset:32240
    s_barrier
    v_mfma_f32_32x32x16_bf16 v[64:79], a[0:3], v[160:163], 0
    ds_read_b128 v[128:131], v1 offset:33280
    ds_read2st64_b32 v[12:13], v4 offset0:0 offset1:1
    v_exp_f32 v60, v60
    v_exp_f32 v61, v61
    v_mfma_f32_32x32x16_bf16 v[64:79], a[4:7], v[164:167], v[64:79]
    ds_read_b128 v[132:135], v1 offset:34304
    ds_read2st64_b32 v[14:15], v4 offset0:2 offset1:3
    v_exp_f32 v62, v62
    v_exp_f32 v63, v63
    v_mfma_f32_32x32x16_bf16 v[64:79], a[8:11], v[168:171], v[64:79]
    ds_read_b128 v[136:139], v1 offset:35328
    v_cvt_pk_bf16_f32 v20, v48, v49
    v_cvt_pk_bf16_f32 v21, v50, v51
    v_cvt_pk_bf16_f32 v22, v52, v53
    v_cvt_pk_bf16_f32 v23, v54, v55
    v_mfma_f32_32x32x16_bf16 v[64:79], a[12:15], v[172:175], v[64:79]
    ds_read_b128 v[140:143], v1 offset:36352
    v_cvt_pk_bf16_f32 v24, v56, v57
    v_cvt_pk_bf16_f32 v25, v58, v59
    v_cvt_pk_bf16_f32 v26, v60, v61
    v_cvt_pk_bf16_f32 v27, v62, v63
    v_mfma_f32_16x16x32_bf16 v[44:47], v[252:255], v[20:23], v[44:47]
    v_mfma_f32_32x32x16_bf16 v[64:79], a[16:19], v[176:179], v[64:79]
    s_waitcnt lgkmcnt(4)
    ds_read_b128 v[144:147], v1 offset:37376
    v_add_f32 v12, v12, v13
    v_mfma_f32_16x16x32_bf16 v[44:47], v[252:255], v[24:27], v[44:47]
    v_mfma_f32_32x32x16_bf16 v[64:79], a[20:23], v[180:183], v[64:79]
    s_waitcnt lgkmcnt(3)
    ds_read_b128 v[148:151], v1 offset:38400
    v_add_f32 v14, v14, v15
    v_add_f32 v8, v12, v14
    v_subrev_u32 v13, s82, v8
    v_cmp_lt_u32 vcc, s83, v13
    v_mfma_f32_32x32x16_bf16 v[64:79], a[24:27], v[184:187], v[64:79]
    ds_read_b128 v[152:155], v1 offset:39424
    ds_write_b32 v3, v44 offset:1024
    s_cbranch_vccnz SLOW_0
    v_mfma_f32_32x32x16_bf16 v[64:79], a[28:31], v[188:191], v[64:79]
    s_waitcnt vmcnt(7)
    ds_read_b128 v[156:159], v1 offset:40448
    ds_write_b32 v3, v45 offset:1088
    v_mov_b32 v38, v8
    v_mfma_f32_32x32x16_bf16 v[80:95], a[224:227], v[128:131], v[80:95]
    s_waitcnt vmcnt(6)
    ds_write_b128 v2, v[20:23] offset:8192
    v_mfma_f32_32x32x16_bf16 v[80:95], a[228:231], v[132:135], v[80:95]
    s_waitcnt vmcnt(5) lgkmcnt(8)
    v_exp_f32 v64, v64
    v_exp_f32 v65, v65
    v_exp_f32 v66, v66
    v_mfma_f32_32x32x16_bf16 v[80:95], a[232:235], v[136:139], v[80:95]
    s_waitcnt vmcnt(4) lgkmcnt(7)
    ds_write_b128 v2, v[24:27] offset:9216
    v_mfma_f32_32x32x16_bf16 v[80:95], a[236:239], v[140:143], v[80:95]
    s_waitcnt vmcnt(3) lgkmcnt(7)
    v_exp_f32 v67, v67
    v_exp_f32 v68, v68
    v_exp_f32 v69, v69
    v_mfma_f32_32x32x16_bf16 v[80:95], a[240:243], v[144:147], v[80:95]
    s_waitcnt vmcnt(2) lgkmcnt(6)
    v_exp_f32 v70, v70
    v_exp_f32 v71, v71
    v_exp_f32 v72, v72
    v_mfma_f32_32x32x16_bf16 v[80:95], a[244:247], v[148:151], v[80:95]
    s_waitcnt vmcnt(1) lgkmcnt(5)
    v_exp_f32 v73, v73
    v_exp_f32 v74, v74
    v_exp_f32 v75, v75
    v_mfma_f32_32x32x16_bf16 v[80:95], a[248:251], v[152:155], v[80:95]
    s_waitcnt vmcnt(0) lgkmcnt(3)
    v_exp_f32 v76, v76
    v_exp_f32 v77, v77
    v_exp_f32 v78, v78
    v_mfma_f32_32x32x16_bf16 v[80:95], a[252:255], v[156:159], v[80:95]
    s_waitcnt lgkmcnt(0)
    s_barrier
    v_mfma_f32_32x32x16_bf16 v[48:63], a[32:35], v[160:163], 0
    ds_read_b128 v[128:131], v1 offset:41472
    v_exp_f32 v79, v79
    v_cvt_pk_bf16_f32 v20, v64, v65
    v_cvt_pk_bf16_f32 v21, v66, v67
    v_mfma_f32_32x32x16_bf16 v[48:63], a[36:39], v[164:167], v[48:63]
    ds_read_b128 v[132:135], v1 offset:42496
    ds_read2st64_b32 v[12:13], v4 offset0:4 offset1:5
    v_cvt_pk_bf16_f32 v22, v68, v69
    v_cvt_pk_bf16_f32 v23, v70, v71
    v_cvt_pk_bf16_f32 v24, v72, v73
    v_mfma_f32_32x32x16_bf16 v[48:63], a[40:43], v[168:171], v[48:63]
    ds_read_b128 v[136:139], v1 offset:43520
    ds_read2st64_b32 v[14:15], v4 offset0:6 offset1:7
    v_cvt_pk_bf16_f32 v25, v74, v75
    v_cvt_pk_bf16_f32 v26, v76, v77
    v_cvt_pk_bf16_f32 v27, v78, v79
    v_mfma_f32_16x16x32_bf16 v[40:43], v[252:255], v[20:23], 0
    v_mfma_f32_32x32x16_bf16 v[48:63], a[44:47], v[172:175], v[48:63]
    ds_read_b128 v[140:143], v1 offset:44544
    v_cvt_pk_bf16_f32 v28, v80, v81
    v_cvt_pk_bf16_f32 v29, v82, v83
    v_cvt_pk_bf16_f32 v30, v84, v85
    v_cvt_pk_bf16_f32 v32, v86, v87
    v_mfma_f32_16x16x32_bf16 v[40:43], v[252:255], v[24:27], v[40:43]
    v_mfma_f32_32x32x16_bf16 v[48:63], a[48:51], v[176:179], v[48:63]
    ds_read_b128 v[144:147], v1 offset:45568
    v_cvt_pk_bf16_f32 v33, v88, v89
    v_cvt_pk_bf16_f32 v34, v90, v91
    v_cvt_pk_bf16_f32 v36, v92, v93
    v_cvt_pk_bf16_f32 v37, v94, v95
    v_mfma_f32_32x32x16_bf16 v[48:63], a[52:55], v[180:183], v[48:63]
    s_waitcnt lgkmcnt(4)
    ds_read_b128 v[148:151], v1 offset:46592
    v_add_f32 v12, v12, v13
    v_mfma_f32_32x32x16_bf16 v[48:63], a[56:59], v[184:187], v[48:63]
    s_waitcnt lgkmcnt(3)
    ds_read_b128 v[152:155], v1 offset:47616
    v_add_f32 v14, v14, v15
    v_add_f32 v9, v12, v14
    v_subrev_u32 v13, s82, v9
    v_cmp_lt_u32 vcc, s83, v13
    v_mfma_f32_32x32x16_bf16 v[48:63], a[60:63], v[188:191], v[48:63]
    ds_read_b128 v[156:159], v1 offset:48640
    s_cbranch_vccnz SLOW_1
    v_mfma_f32_32x32x16_bf16 v[96:111], a[224:227], v[128:131], v[96:111]
    ds_write_b128 v2, v[20:23] offset:0
    v_mfma_f32_32x32x16_bf16 v[96:111], a[228:231], v[132:135], v[96:111]
    v_exp_f32 v48, v48
    v_exp_f32 v49, v49
    v_exp_f32 v50, v50
    v_mfma_f32_32x32x16_bf16 v[96:111], a[232:235], v[136:139], v[96:111]
    s_waitcnt lgkmcnt(5)
    ds_write_b128 v2, v[24:27] offset:1024
    v_mfma_f32_32x32x16_bf16 v[96:111], a[236:239], v[140:143], v[96:111]
    s_waitcnt lgkmcnt(5)
    v_exp_f32 v51, v51
    v_exp_f32 v52, v52
    v_exp_f32 v53, v53
    v_mfma_f32_32x32x16_bf16 v[96:111], a[240:243], v[144:147], v[96:111]
    s_waitcnt lgkmcnt(4)
    buffer_store_dwordx4 v[28:31], v1, s[32:35], s74 offen sc1
    v_mfma_f32_32x32x16_bf16 v[96:111], a[244:247], v[148:151], v[96:111]
    s_waitcnt lgkmcnt(3)
    v_exp_f32 v54, v54
    v_exp_f32 v55, v55
    v_exp_f32 v56, v56
    v_mfma_f32_32x32x16_bf16 v[96:111], a[248:251], v[152:155], v[96:111]
    s_waitcnt lgkmcnt(2)
    v_exp_f32 v57, v57
    v_exp_f32 v58, v58
    v_exp_f32 v59, v59
    v_mfma_f32_32x32x16_bf16 v[96:111], a[252:255], v[156:159], v[96:111]
    s_waitcnt lgkmcnt(0)
    s_barrier
    v_mfma_f32_32x32x16_bf16 v[64:79], a[64:67], v[160:163], 0
    ds_read_b128 v[128:131], v1 offset:33280
    v_exp_f32 v60, v60
    v_exp_f32 v61, v61
    v_mfma_f32_32x32x16_bf16 v[64:79], a[68:71], v[164:167], v[64:79]
    ds_read_b128 v[132:135], v1 offset:34304
    v_exp_f32 v62, v62
    v_exp_f32 v63, v63
    v_mfma_f32_32x32x16_bf16 v[64:79], a[72:75], v[168:171], v[64:79]
    ds_read_b128 v[136:139], v1 offset:35328
    v_cvt_pk_bf16_f32 v20, v48, v49
    v_cvt_pk_bf16_f32 v21, v50, v51
    v_cvt_pk_bf16_f32 v22, v52, v53
    v_cvt_pk_bf16_f32 v23, v54, v55
    v_mfma_f32_32x32x16_bf16 v[64:79], a[76:79], v[172:175], v[64:79]
    ds_read_b128 v[140:143], v1 offset:36352
    v_cvt_pk_bf16_f32 v24, v56, v57
    v_cvt_pk_bf16_f32 v25, v58, v59
    v_cvt_pk_bf16_f32 v26, v60, v61
    v_cvt_pk_bf16_f32 v27, v62, v63
    v_mfma_f32_16x16x32_bf16 v[40:43], v[252:255], v[20:23], v[40:43]
    v_mfma_f32_32x32x16_bf16 v[64:79], a[80:83], v[176:179], v[64:79]
    ds_read_b128 v[144:147], v1 offset:37376
    v_cvt_pk_bf16_f32 v28, v96, v97
    v_cvt_pk_bf16_f32 v29, v98, v99
    v_cvt_pk_bf16_f32 v30, v100, v101
    v_mfma_f32_16x16x32_bf16 v[40:43], v[252:255], v[24:27], v[40:43]
    v_mfma_f32_32x32x16_bf16 v[64:79], a[84:87], v[180:183], v[64:79]
    ds_read_b128 v[148:151], v1 offset:38400
    v_mfma_f32_32x32x16_bf16 v[64:79], a[88:91], v[184:187], v[64:79]
    ds_read_b128 v[152:155], v1 offset:39424
    v_mfma_f32_32x32x16_bf16 v[64:79], a[92:95], v[188:191], v[64:79]
    s_waitcnt lgkmcnt(6)
    ds_read_b128 v[156:159], v1 offset:40448
    v_mfma_f32_32x32x16_bf16 v[112:127], a[128:131], v[128:131], 0
    s_waitcnt lgkmcnt(6)
    ds_write_b128 v2, v[20:23] offset:8192
    v_mfma_f32_32x32x16_bf16 v[112:127], a[132:135], v[132:135], v[112:127]
    s_waitcnt lgkmcnt(6)
    v_exp_f32 v64, v64
    v_exp_f32 v65, v65
    v_exp_f32 v66, v66
    v_mfma_f32_32x32x16_bf16 v[112:127], a[136:139], v[136:139], v[112:127]
    s_waitcnt lgkmcnt(5)
    ds_write_b128 v2, v[24:27] offset:9216
    v_mfma_f32_32x32x16_bf16 v[112:127], a[140:143], v[140:143], v[112:127]
    s_waitcnt lgkmcnt(5)
    v_exp_f32 v67, v67
    v_exp_f32 v68, v68
    v_exp_f32 v69, v69
    v_mfma_f32_32x32x16_bf16 v[112:127], a[144:147], v[144:147], v[112:127]
    s_waitcnt lgkmcnt(4)
    buffer_store_dwordx4 v[32:35], v1, s[32:35], s74 offen offset:1024 sc1
    v_mfma_f32_32x32x16_bf16 v[112:127], a[148:151], v[148:151], v[112:127]
    s_waitcnt lgkmcnt(3)
    v_exp_f32 v70, v70
    v_cvt_pk_bf16_f32 v32, v102, v103
    v_cvt_pk_bf16_f32 v33, v104, v105
    v_cvt_pk_bf16_f32 v34, v106, v107
    v_mfma_f32_32x32x16_bf16 v[112:127], a[152:155], v[152:155], v[112:127]
    s_waitcnt lgkmcnt(2)
    buffer_store_dwordx4 v[28:31], v1, s[32:35], s75 offen sc1
    v_mfma_f32_32x32x16_bf16 v[112:127], a[156:159], v[156:159], v[112:127]
    s_waitcnt lgkmcnt(0)
    s_barrier
    v_mfma_f32_32x32x16_bf16 v[48:63], a[96:99], v[160:163], 0
    ds_read_b128 v[128:131], v1 offset:41472
    v_exp_f32 v71, v71
    v_exp_f32 v72, v72
    v_mfma_f32_32x32x16_bf16 v[48:63], a[100:103], v[164:167], v[48:63]
    ds_read_b128 v[132:135], v1 offset:42496
    v_exp_f32 v73, v73
    v_exp_f32 v74, v74
    v_mfma_f32_32x32x16_bf16 v[48:63], a[104:107], v[168:171], v[48:63]
    ds_read_b128 v[136:139], v1 offset:43520
    v_exp_f32 v75, v75
    v_exp_f32 v76, v76
    v_mfma_f32_32x32x16_bf16 v[48:63], a[108:111], v[172:175], v[48:63]
    ds_read_b128 v[140:143], v1 offset:44544
    v_exp_f32 v77, v77
    v_exp_f32 v78, v78
    v_mfma_f32_32x32x16_bf16 v[48:63], a[112:115], v[176:179], v[48:63]
    ds_read_b128 v[144:147], v1 offset:45568
    v_exp_f32 v79, v79
    v_cvt_pk_bf16_f32 v20, v64, v65
    v_cvt_pk_bf16_f32 v21, v66, v67
    v_mfma_f32_32x32x16_bf16 v[48:63], a[116:119], v[180:183], v[48:63]
    ds_read_b128 v[148:151], v1 offset:46592
    v_cvt_pk_bf16_f32 v22, v68, v69
    v_cvt_pk_bf16_f32 v23, v70, v71
    v_cvt_pk_bf16_f32 v24, v72, v73
    v_cvt_pk_bf16_f32 v25, v74, v75
    v_mfma_f32_32x32x16_bf16 v[48:63], a[120:123], v[184:187], v[48:63]
    ds_read_b128 v[152:155], v1 offset:47616
    v_cvt_pk_bf16_f32 v26, v76, v77
    v_cvt_pk_bf16_f32 v27, v78, v79
    v_mfma_f32_16x16x32_bf16 v[40:43], v[252:255], v[20:23], v[40:43]
    v_mfma_f32_32x32x16_bf16 v[48:63], a[124:127], v[188:191], v[48:63]
    ds_read_b128 v[156:159], v1 offset:48640
    v_mfma_f32_16x16x32_bf16 v[40:43], v[252:255], v[24:27], v[40:43]
    s_waitcnt lgkmcnt(7)
    v_mfma_f32_32x32x16_bf16 v[112:127], a[160:163], v[128:131], v[112:127]
    s_waitcnt lgkmcnt(6)
    ds_write_b128 v2, v[20:23] offset:0
    v_mfma_f32_32x32x16_bf16 v[112:127], a[164:167], v[132:135], v[112:127]
    s_waitcnt lgkmcnt(6)
    v_exp_f32 v48, v48
    v_exp_f32 v49, v49
    v_exp_f32 v50, v50
    v_mfma_f32_32x32x16_bf16 v[112:127], a[168:171], v[136:139], v[112:127]
    s_waitcnt lgkmcnt(5)
    ds_write_b128 v2, v[24:27] offset:1024
    v_mfma_f32_32x32x16_bf16 v[112:127], a[172:175], v[140:143], v[112:127]
    s_waitcnt lgkmcnt(5)
    buffer_store_dwordx4 v[36:39], v1, s[32:35], s74 offen offset:2048 sc1
    v_mfma_f32_32x32x16_bf16 v[112:127], a[176:179], v[144:147], v[112:127]
    s_waitcnt lgkmcnt(4)
    v_exp_f32 v51, v51
    v_mov_b32 v38, v9
    v_cvt_pk_bf16_f32 v36, v108, v109
    v_cvt_pk_bf16_f32 v37, v110, v111
    v_mfma_f32_32x32x16_bf16 v[112:127], a[180:183], v[148:151], v[112:127]
    s_waitcnt lgkmcnt(3)
    buffer_store_dwordx4 v[32:35], v1, s[32:35], s75 offen offset:1024 sc1
    v_mfma_f32_32x32x16_bf16 v[112:127], a[184:187], v[152:155], v[112:127]
    s_waitcnt lgkmcnt(2)
    v_exp_f32 v52, v52
    v_exp_f32 v53, v53
    v_exp_f32 v54, v54
    v_mfma_f32_32x32x16_bf16 v[112:127], a[188:191], v[156:159], v[112:127]
    s_waitcnt lgkmcnt(0)
    s_barrier
    v_mfma_f32_32x32x16_bf16 v[64:79], a[0:3], v[192:195], 0
    ds_read_b128 v[128:131], v1 offset:33280
    v_exp_f32 v55, v55
    v_exp_f32 v56, v56
    v_mfma_f32_32x32x16_bf16 v[64:79], a[4:7], v[196:199], v[64:79]
    ds_read_b128 v[132:135], v1 offset:34304
    v_exp_f32 v57, v57
    v_exp_f32 v58, v58
    v_mfma_f32_32x32x16_bf16 v[64:79], a[8:11], v[200:203], v[64:79]
    ds_read_b128 v[136:139], v1 offset:35328
    v_exp_f32 v59, v59
    v_exp_f32 v60, v60
    v_mfma_f32_32x32x16_bf16 v[64:79], a[12:15], v[204:207], v[64:79]
    ds_read_b128 v[140:143], v1 offset:36352
    v_exp_f32 v61, v61
    v_exp_f32 v62, v62
    v_mfma_f32_32x32x16_bf16 v[64:79], a[16:19], v[208:211], v[64:79]
    ds_read_b128 v[144:147], v1 offset:37376
    v_exp_f32 v63, v63
    v_cvt_pk_bf16_f32 v20, v48, v49
    v_cvt_pk_bf16_f32 v21, v50, v51
    v_mfma_f32_32x32x16_bf16 v[64:79], a[20:23], v[212:215], v[64:79]
    ds_read_b128 v[148:151], v1 offset:38400
    v_cvt_pk_bf16_f32 v22, v52, v53
    v_cvt_pk_bf16_f32 v23, v54, v55
    v_cvt_pk_bf16_f32 v24, v56, v57
    v_cvt_pk_bf16_f32 v25, v58, v59
    v_mfma_f32_32x32x16_bf16 v[64:79], a[24:27], v[216:219], v[64:79]
    ds_read_b128 v[152:155], v1 offset:39424
    v_cvt_pk_bf16_f32 v26, v60, v61
    v_cvt_pk_bf16_f32 v27, v62, v63
    v_mfma_f32_16x16x32_bf16 v[40:43], v[252:255], v[20:23], v[40:43]
    v_mfma_f32_32x32x16_bf16 v[64:79], a[28:31], v[220:223], v[64:79]
    ds_read_b128 v[156:159], v1 offset:40448
    v_mfma_f32_16x16x32_bf16 v[40:43], v[252:255], v[24:27], v[40:43]
    s_waitcnt lgkmcnt(7)
    v_mfma_f32_32x32x16_bf16 v[112:127], a[192:195], v[128:131], v[112:127]
    s_waitcnt lgkmcnt(6)
    ds_write_b128 v2, v[20:23] offset:8192
    v_mfma_f32_32x32x16_bf16 v[112:127], a[196:199], v[132:135], v[112:127]
    s_waitcnt lgkmcnt(6)
    ds_write_b128 v2, v[24:27] offset:9216
    ds_write_b32 v3, v40 offset:2048
    v_mfma_f32_32x32x16_bf16 v[112:127], a[200:203], v[136:139], v[112:127]
    s_waitcnt lgkmcnt(7)
    ds_write_b32 v3, v41 offset:2112
    v_exp_f32 v64, v64
    v_exp_f32 v65, v65
    v_mfma_f32_32x32x16_bf16 v[112:127], a[204:207], v[140:143], v[112:127]
    s_waitcnt lgkmcnt(0)
    buffer_store_dwordx4 v[36:39], v1, s[32:35], s75 offen offset:2048 sc1
    s_barrier
    v_mfma_f32_32x32x16_bf16 v[112:127], a[208:211], v[144:147], v[112:127]
    ds_read_b128 v[128:131], v1 offset:41472
    ds_read_b128 v[132:135], v1 offset:42496
    v_exp_f32 v66, v66
    v_exp_f32 v67, v67
    v_mfma_f32_32x32x16_bf16 v[112:127], a[212:215], v[148:151], v[112:127]
    ds_read2st64_b32 v[12:13], v4 offset0:8 offset1:9
    ds_read2st64_b32 v[14:15], v4 offset0:10 offset1:11
    v_exp_f32 v68, v68
    v_exp_f32 v69, v69
    v_mfma_f32_32x32x16_bf16 v[112:127], a[216:219], v[152:155], v[112:127]
    ds_read_b128 v[136:139], v1 offset:43520
    ds_read_b128 v[140:143], v1 offset:44544
    v_exp_f32 v70, v70
    v_exp_f32 v71, v71
    v_mfma_f32_32x32x16_bf16 v[112:127], a[220:223], v[156:159], v[112:127]
    s_waitcnt lgkmcnt(5)
    ds_read_b128 v[144:147], v1 offset:45568
    ds_read_b128 v[148:151], v1 offset:46592
    v_exp_f32 v72, v72
    v_exp_f32 v73, v73
    v_mfma_f32_32x32x16_bf16 v[112:127], a[224:227], v[128:131], v[112:127]
    s_waitcnt lgkmcnt(6)
    ds_read_b128 v[152:155], v1 offset:47616
    ds_read_b128 v[156:159], v1 offset:48640
    v_exp_f32 v74, v74
    v_exp_f32 v75, v75
    v_mfma_f32_32x32x16_bf16 v[112:127], a[228:231], v[132:135], v[112:127]
    s_waitcnt lgkmcnt(5)
    v_exp_f32 v76, v76
    v_exp_f32 v77, v77
    v_exp_f32 v78, v78
    v_mfma_f32_32x32x16_bf16 v[112:127], a[232:235], v[136:139], v[112:127]
    s_waitcnt lgkmcnt(4)
    v_exp_f32 v79, v79
    v_add_f32 v12, v12, v13
    v_add_f32 v14, v14, v15
    v_add_f32 v10, v12, v14
    v_subrev_u32 v13, s82, v10
    v_mfma_f32_32x32x16_bf16 v[112:127], a[236:239], v[140:143], v[112:127]
    s_waitcnt lgkmcnt(3)
    v_cmp_lt_u32 vcc, s83, v13
    v_cvt_pk_bf16_f32 v20, v64, v65
    v_cvt_pk_bf16_f32 v21, v66, v67
    v_cvt_pk_bf16_f32 v22, v68, v69
    v_cvt_pk_bf16_f32 v23, v70, v71
    v_mfma_f32_32x32x16_bf16 v[112:127], a[240:243], v[144:147], v[112:127]
    ds_write_b128 v2, v[20:23] offset:0
    v_mfma_f32_16x16x32_bf16 v[44:47], v[252:255], v[20:23], 0
    s_waitcnt lgkmcnt(3)
    v_mfma_f32_32x32x16_bf16 v[112:127], a[244:247], v[148:151], v[112:127]
    s_cbranch_vccnz SLOW_2
    v_cvt_pk_bf16_f32 v24, v72, v73
    v_cvt_pk_bf16_f32 v25, v74, v75
    s_waitcnt lgkmcnt(2)
    v_mfma_f32_32x32x16_bf16 v[112:127], a[248:251], v[152:155], v[112:127]
    s_waitcnt lgkmcnt(1)
    v_cvt_pk_bf16_f32 v26, v76, v77
    v_cvt_pk_bf16_f32 v27, v78, v79
    v_mov_b32 v38, v10
    v_mfma_f32_32x32x16_bf16 v[112:127], a[252:255], v[156:159], v[112:127]
    ds_write_b128 v2, v[24:27] offset:1024
    v_mfma_f32_16x16x32_bf16 v[44:47], v[252:255], v[24:27], v[44:47]
    v_mfma_f32_32x32x16_bf16 v[48:63], a[32:35], v[192:195], 0
    v_mfma_f32_32x32x16_bf16 v[48:63], a[36:39], v[196:199], v[48:63]
    v_cvt_pk_bf16_f32 v28, v112, v113
    v_cvt_pk_bf16_f32 v29, v114, v115
    v_cvt_pk_bf16_f32 v30, v116, v117
    v_cvt_pk_bf16_f32 v32, v118, v119
    v_cvt_pk_bf16_f32 v33, v120, v121
    v_mfma_f32_32x32x16_bf16 v[48:63], a[40:43], v[200:203], v[48:63]
    buffer_store_dwordx4 v[28:31], v1, s[32:35], s76 offen sc1
    v_mfma_f32_32x32x16_bf16 v[48:63], a[44:47], v[204:207], v[48:63]
    v_cvt_pk_bf16_f32 v34, v122, v123
    v_cvt_pk_bf16_f32 v36, v124, v125
    v_cvt_pk_bf16_f32 v37, v126, v127
    v_mfma_f32_32x32x16_bf16 v[48:63], a[48:51], v[208:211], v[48:63]
    buffer_store_dwordx4 v[32:35], v1, s[32:35], s76 offen offset:1024 sc1
    v_mfma_f32_32x32x16_bf16 v[48:63], a[52:55], v[212:215], v[48:63]
    v_mfma_f32_32x32x16_bf16 v[48:63], a[56:59], v[216:219], v[48:63]
    buffer_store_dwordx4 v[36:39], v1, s[32:35], s76 offen offset:2048 sc1
    v_mfma_f32_32x32x16_bf16 v[48:63], a[60:63], v[220:223], v[48:63]
    s_waitcnt lgkmcnt(0)
    s_barrier
    v_mfma_f32_32x32x16_bf16 v[64:79], a[64:67], v[192:195], 0
    ds_read_b128 v[128:131], v1 offset:33280
    v_mfma_f32_32x32x16_bf16 v[64:79], a[68:71], v[196:199], v[64:79]
    ds_read_b128 v[132:135], v1 offset:34304
    v_exp_f32 v48, v48
    v_exp_f32 v49, v49
    v_mfma_f32_32x32x16_bf16 v[64:79], a[72:75], v[200:203], v[64:79]
    ds_read_b128 v[136:139], v1 offset:35328
    v_exp_f32 v50, v50
    v_exp_f32 v51, v51
    v_mfma_f32_32x32x16_bf16 v[64:79], a[76:79], v[204:207], v[64:79]
    ds_read_b128 v[140:143], v1 offset:36352
    v_exp_f32 v52, v52
    v_exp_f32 v53, v53
    v_mfma_f32_32x32x16_bf16 v[64:79], a[80:83], v[208:211], v[64:79]
    ds_read_b128 v[144:147], v1 offset:37376
    v_exp_f32 v54, v54
    v_exp_f32 v55, v55
    v_mfma_f32_32x32x16_bf16 v[64:79], a[84:87], v[212:215], v[64:79]
    ds_read_b128 v[148:151], v1 offset:38400
    v_exp_f32 v56, v56
    v_exp_f32 v57, v57
    v_mfma_f32_32x32x16_bf16 v[64:79], a[88:91], v[216:219], v[64:79]
    ds_read_b128 v[152:155], v1 offset:39424
    v_exp_f32 v58, v58
    v_exp_f32 v59, v59
    v_mfma_f32_32x32x16_bf16 v[64:79], a[92:95], v[220:223], v[64:79]
    s_waitcnt lgkmcnt(6)
    ds_read_b128 v[156:159], v1 offset:40448
    v_exp_f32 v60, v60
    v_exp_f32 v61, v61
    v_mfma_f32_32x32x16_bf16 v[224:239], a[128:131], v[128:131], 0
    s_waitcnt lgkmcnt(6)
    v_exp_f32 v62, v62
    v_exp_f32 v63, v63
    v_cvt_pk_bf16_f32 v20, v48, v49
    v_mfma_f32_32x32x16_bf16 v[224:239], a[132:135], v[132:135], v[224:239]
    s_waitcnt lgkmcnt(5)
    v_cvt_pk_bf16_f32 v21, v50, v51
    v_cvt_pk_bf16_f32 v22, v52, v53
    v_cvt_pk_bf16_f32 v23, v54, v55
    v_cvt_pk_bf16_f32 v24, v56, v57
    v_cvt_pk_bf16_f32 v25, v58, v59
    v_mfma_f32_32x32x16_bf16 v[224:239], a[136:139], v[136:139], v[224:239]
    ds_write_b128 v2, v[20:23] offset:8192
    v_mfma_f32_16x16x32_bf16 v[44:47], v[252:255], v[20:23], v[44:47]
    s_waitcnt lgkmcnt(5)
    v_mfma_f32_32x32x16_bf16 v[224:239], a[140:143], v[140:143], v[224:239]
    s_waitcnt lgkmcnt(4)
    v_exp_f32 v64, v64
    v_cvt_pk_bf16_f32 v26, v60, v61
    v_cvt_pk_bf16_f32 v27, v62, v63
    v_mfma_f32_32x32x16_bf16 v[224:239], a[144:147], v[144:147], v[224:239]
    ds_write_b128 v2, v[24:27] offset:9216
    v_mfma_f32_16x16x32_bf16 v[44:47], v[252:255], v[24:27], v[44:47]
    s_waitcnt lgkmcnt(4)
    v_mfma_f32_32x32x16_bf16 v[224:239], a[148:151], v[148:151], v[224:239]
    s_waitcnt lgkmcnt(3)
    v_exp_f32 v65, v65
    v_exp_f32 v66, v66
    v_exp_f32 v67, v67
    v_mfma_f32_32x32x16_bf16 v[224:239], a[152:155], v[152:155], v[224:239]
    s_waitcnt lgkmcnt(2)
    v_exp_f32 v68, v68
    v_exp_f32 v69, v69
    v_exp_f32 v70, v70
    v_mfma_f32_32x32x16_bf16 v[224:239], a[156:159], v[156:159], v[224:239]
    s_waitcnt lgkmcnt(0)
    s_barrier
    v_mfma_f32_32x32x16_bf16 v[48:63], a[96:99], v[192:195], 0
    ds_read_b128 v[128:131], v1 offset:41472
    v_exp_f32 v71, v71
    v_exp_f32 v72, v72
    v_mfma_f32_32x32x16_bf16 v[48:63], a[100:103], v[196:199], v[48:63]
    ds_read_b128 v[132:135], v1 offset:42496
    v_exp_f32 v73, v73
    v_exp_f32 v74, v74
    v_mfma_f32_32x32x16_bf16 v[48:63], a[104:107], v[200:203], v[48:63]
    ds_read_b128 v[136:139], v1 offset:43520
    v_exp_f32 v75, v75
    v_exp_f32 v76, v76
    v_mfma_f32_32x32x16_bf16 v[48:63], a[108:111], v[204:207], v[48:63]
    ds_read_b128 v[140:143], v1 offset:44544
    v_exp_f32 v77, v77
    v_exp_f32 v78, v78
    v_mfma_f32_32x32x16_bf16 v[48:63], a[112:115], v[208:211], v[48:63]
    ds_read_b128 v[144:147], v1 offset:45568
    v_exp_f32 v79, v79
    v_cvt_pk_bf16_f32 v20, v64, v65
    v_cvt_pk_bf16_f32 v21, v66, v67
    v_mfma_f32_32x32x16_bf16 v[48:63], a[116:119], v[212:215], v[48:63]
    ds_read_b128 v[148:151], v1 offset:46592
    v_cvt_pk_bf16_f32 v22, v68, v69
    v_cvt_pk_bf16_f32 v23, v70, v71
    v_cvt_pk_bf16_f32 v24, v72, v73
    v_cvt_pk_bf16_f32 v25, v74, v75
    v_mfma_f32_32x32x16_bf16 v[48:63], a[120:123], v[216:219], v[48:63]
    ds_read_b128 v[152:155], v1 offset:47616
    v_cvt_pk_bf16_f32 v26, v76, v77
    v_cvt_pk_bf16_f32 v27, v78, v79
    v_mfma_f32_16x16x32_bf16 v[44:47], v[252:255], v[20:23], v[44:47]
    v_mfma_f32_32x32x16_bf16 v[48:63], a[124:127], v[220:223], v[48:63]
    ds_read_b128 v[156:159], v1 offset:48640
    v_mfma_f32_16x16x32_bf16 v[44:47], v[252:255], v[24:27], v[44:47]
    s_waitcnt lgkmcnt(7)
    v_mfma_f32_32x32x16_bf16 v[224:239], a[160:163], v[128:131], v[224:239]
    s_waitcnt lgkmcnt(6)
    ds_write_b128 v2, v[20:23] offset:0
    v_mfma_f32_32x32x16_bf16 v[224:239], a[164:167], v[132:135], v[224:239]
    s_waitcnt lgkmcnt(6)
    ds_write_b128 v2, v[24:27] offset:1024
    v_mfma_f32_32x32x16_bf16 v[224:239], a[168:171], v[136:139], v[224:239]
    s_waitcnt lgkmcnt(6)
    buffer_load_dwordx4 v[80:83], v1, s[32:35], s77 offen sc1
    v_exp_f32 v48, v48
    v_exp_f32 v49, v49
    v_mfma_f32_32x32x16_bf16 v[224:239], a[172:175], v[140:143], v[224:239]
    s_waitcnt lgkmcnt(0)
    buffer_load_dwordx4 v[84:87], v1, s[32:35], s77 offen offset:1024 sc1
    buffer_load_dwordx4 v[88:91], v1, s[32:35], s77 offen offset:2048 sc1
    s_barrier
    v_mfma_f32_32x32x16_bf16 v[224:239], a[176:179], v[144:147], v[224:239]
    ds_read_b128 v[128:131], v1 offset:33280
    ds_read_b128 v[132:135], v1 offset:34304
    v_exp_f32 v50, v50
    v_exp_f32 v51, v51
    v_mfma_f32_32x32x16_bf16 v[224:239], a[180:183], v[148:151], v[224:239]
    ds_read_b128 v[136:139], v1 offset:35328
    ds_read_b128 v[140:143], v1 offset:36352
    v_exp_f32 v52, v52
    v_exp_f32 v53, v53
    v_mfma_f32_32x32x16_bf16 v[224:239], a[184:187], v[152:155], v[224:239]
    ds_read_b128 v[144:147], v1 offset:37376
    ds_read_b128 v[148:151], v1 offset:38400
    v_exp_f32 v54, v54
    v_exp_f32 v55, v55
    v_mfma_f32_32x32x16_bf16 v[224:239], a[188:191], v[156:159], v[224:239]
    s_waitcnt lgkmcnt(5)
    v_exp_f32 v56, v56
    v_exp_f32 v57, v57
    v_exp_f32 v58, v58
    v_exp_f32 v59, v59
    v_exp_f32 v60, v60
    v_exp_f32 v61, v61
    v_exp_f32 v62, v62
    v_exp_f32 v63, v63
    v_mfma_f32_32x32x16_bf16 v[224:239], a[192:195], v[128:131], v[224:239]
    s_waitcnt lgkmcnt(4)
    v_cvt_pk_bf16_f32 v20, v48, v49
    v_cvt_pk_bf16_f32 v21, v50, v51
    v_cvt_pk_bf16_f32 v22, v52, v53
    v_cvt_pk_bf16_f32 v23, v54, v55
    v_cvt_pk_bf16_f32 v24, v56, v57
    v_cvt_pk_bf16_f32 v25, v58, v59
    v_cvt_pk_bf16_f32 v26, v60, v61
    v_cvt_pk_bf16_f32 v27, v62, v63
    v_mfma_f32_32x32x16_bf16 v[224:239], a[196:199], v[132:135], v[224:239]
    s_waitcnt lgkmcnt(3)
    buffer_load_dwordx4 v[92:95], v1, s[32:35], s78 offen sc1
    buffer_load_dwordx4 v[96:99], v1, s[32:35], s78 offen offset:1024 sc1
    buffer_load_dwordx4 v[100:103], v1, s[32:35], s78 offen offset:2048 sc1
    ds_write_b128 v2, v[20:23] offset:8192
    ds_write_b128 v2, v[24:27] offset:9216
    v_mfma_f32_32x32x16_bf16 v[224:239], a[200:203], v[136:139], v[224:239]
    ds_read_b128 v[152:155], v1 offset:39424
    ds_read_b128 v[156:159], v1 offset:40448
    v_mfma_f32_16x16x32_bf16 v[44:47], v[252:255], v[20:23], v[44:47]
    s_waitcnt lgkmcnt(6)
    v_mfma_f32_32x32x16_bf16 v[224:239], a[204:207], v[140:143], v[224:239]
    v_mfma_f32_16x16x32_bf16 v[44:47], v[252:255], v[24:27], v[44:47]
    s_waitcnt lgkmcnt(5)
    v_mfma_f32_32x32x16_bf16 v[224:239], a[208:211], v[144:147], v[224:239]
    s_waitcnt lgkmcnt(0)
    s_barrier
    v_mfma_f32_32x32x16_bf16 v[224:239], a[212:215], v[148:151], v[224:239]
    ds_read_b128 v[128:131], v1 offset:41472
    ds_read_b128 v[132:135], v1 offset:42496
    ds_write_b32 v3, v44 offset:3072
    ds_write_b32 v3, v45 offset:3136
    v_mfma_f32_32x32x16_bf16 v[224:239], a[216:219], v[152:155], v[224:239]
    ds_read_b128 v[136:139], v1 offset:43520
    ds_read_b128 v[140:143], v1 offset:44544
    v_mfma_f32_32x32x16_bf16 v[224:239], a[220:223], v[156:159], v[224:239]
    s_waitcnt lgkmcnt(5)
    ds_read_b128 v[144:147], v1 offset:45568
    ds_read_b128 v[148:151], v1 offset:46592
    v_mfma_f32_32x32x16_bf16 v[224:239], a[224:227], v[128:131], v[224:239]
    s_waitcnt lgkmcnt(6)
    ds_read_b128 v[152:155], v1 offset:47616
    ds_read_b128 v[156:159], v1 offset:48640
    v_mfma_f32_32x32x16_bf16 v[224:239], a[228:231], v[132:135], v[224:239]
    s_waitcnt lgkmcnt(5)
    v_mfma_f32_32x32x16_bf16 v[224:239], a[232:235], v[136:139], v[224:239]
    s_waitcnt lgkmcnt(4)
    buffer_load_dwordx4 v[104:107], v1, s[32:35], s79 offen sc1
    v_mfma_f32_32x32x16_bf16 v[224:239], a[236:239], v[140:143], v[224:239]
    s_waitcnt lgkmcnt(3)
    buffer_load_dwordx4 v[108:111], v1, s[32:35], s79 offen offset:1024 sc1
    v_mfma_f32_32x32x16_bf16 v[224:239], a[240:243], v[144:147], v[224:239]
    s_waitcnt lgkmcnt(2)
    buffer_load_dwordx4 v[112:115], v1, s[32:35], s79 offen offset:2048 sc1
    v_mfma_f32_32x32x16_bf16 v[224:239], a[244:247], v[148:151], v[224:239]
    s_waitcnt lgkmcnt(1)
    v_mfma_f32_32x32x16_bf16 v[224:239], a[248:251], v[152:155], v[224:239]
    s_waitcnt lgkmcnt(0)
    v_mfma_f32_32x32x16_bf16 v[224:239], a[252:255], v[156:159], v[224:239]
    s_nop 7
    s_mov_b64 s[84:85], 0
    s_waitcnt lgkmcnt(0)
    s_barrier
    ds_read2st64_b32 v[16:17], v4 offset0:12 offset1:13
    ds_read2st64_b32 v[18:19], v4 offset0:14 offset1:15
    s_nop 3
    s_waitcnt vmcnt(8)
    v_cmp_ne_u32 vcc, s56, v83
    s_or_b64 s[84:85], s[84:85], vcc
    s_waitcnt vmcnt(7)
    v_cmp_ne_u32 vcc, s56, v87
    s_or_b64 s[84:85], s[84:85], vcc
    s_waitcnt vmcnt(6)
    v_cmp_ne_u32 vcc, s56, v91
    s_or_b64 s[84:85], s[84:85], vcc
    s_waitcnt vmcnt(5)
    v_cmp_ne_u32 vcc, s56, v95
    s_or_b64 s[84:85], s[84:85], vcc
    s_waitcnt vmcnt(4)
    v_cmp_ne_u32 vcc, s56, v99
    s_or_b64 s[84:85], s[84:85], vcc
    s_waitcnt vmcnt(3)
    v_cmp_ne_u32 vcc, s56, v103
    s_or_b64 s[84:85], s[84:85], vcc
    v_lshlrev_b32 v240, 16, v80
    v_and_b32 v241, s81, v80
    v_lshlrev_b32 v242, 16, v81
    v_and_b32 v243, s81, v81
    v_lshlrev_b32 v244, 16, v82
    v_and_b32 v245, s81, v82
    v_lshlrev_b32 v246, 16, v84
    v_and_b32 v247, s81, v84
    v_lshlrev_b32 v248, 16, v85
    v_and_b32 v249, s81, v85
    v_lshlrev_b32 v250, 16, v86
    v_and_b32 v251, s81, v86
    v_lshlrev_b32 v252, 16, v88
    v_and_b32 v253, s81, v88
    v_lshlrev_b32 v254, 16, v89
    v_and_b32 v255, s81, v89
    v_lshlrev_b32 v14, 16, v92
    v_add_f32 v240, v240, v14
    v_and_b32 v15, s81, v92
    v_add_f32 v241, v241, v15
    v_lshlrev_b32 v14, 16, v93
    v_add_f32 v242, v242, v14
    v_and_b32 v15, s81, v93
    v_add_f32 v243, v243, v15
    v_lshlrev_b32 v14, 16, v94
    v_add_f32 v244, v244, v14
    v_and_b32 v15, s81, v94
    v_add_f32 v245, v245, v15
    v_lshlrev_b32 v14, 16, v96
    v_add_f32 v246, v246, v14
    v_and_b32 v15, s81, v96
    v_add_f32 v247, v247, v15
    v_lshlrev_b32 v14, 16, v97
    v_add_f32 v248, v248, v14
    v_and_b32 v15, s81, v97
    v_add_f32 v249, v249, v15
    v_lshlrev_b32 v14, 16, v98
    v_add_f32 v250, v250, v14
    v_and_b32 v15, s81, v98
    v_add_f32 v251, v251, v15
    v_lshlrev_b32 v14, 16, v100
    v_add_f32 v252, v252, v14
    v_and_b32 v15, s81, v100
    v_add_f32 v253, v253, v15
    v_lshlrev_b32 v14, 16, v101
    v_add_f32 v254, v254, v14
    v_and_b32 v15, s81, v101
    v_add_f32 v255, v255, v15
    s_waitcnt lgkmcnt(1)
    v_add_f32 v16, v16, v17
    s_waitcnt lgkmcnt(0)
    v_add_f32 v18, v18, v19
    v_add_f32 v11, v16, v18
    v_subrev_u32 v17, s82, v11
    v_cmp_lt_u32 vcc, s83, v17
    s_cbranch_vccnz SLOW_3
    v_add_f32 v240, v240, v224
    v_add_f32 v241, v241, v225
    v_add_f32 v242, v242, v226
    v_add_f32 v243, v243, v227
    v_add_f32 v244, v244, v228
    v_add_f32 v245, v245, v229
    v_add_f32 v246, v246, v230
    v_add_f32 v247, v247, v231
    v_add_f32 v248, v248, v232
    v_add_f32 v249, v249, v233
    v_add_f32 v250, v250, v234
    v_add_f32 v251, v251, v235
    v_add_f32 v252, v252, v236
    v_add_f32 v253, v253, v237
    v_add_f32 v254, v254, v238
    v_add_f32 v255, v255, v239
    s_waitcnt vmcnt(2)
    v_cmp_ne_u32 vcc, s56, v107
    s_or_b64 s[84:85], s[84:85], vcc
    s_waitcnt vmcnt(1)
    v_cmp_ne_u32 vcc, s56, v111
    s_or_b64 s[84:85], s[84:85], vcc
    s_waitcnt vmcnt(0)
    v_cmp_ne_u32 vcc, s56, v115
    s_or_b64 s[84:85], s[84:85], vcc
    s_cmp_lg_u64 s[84:85], 0
    s_cbranch_scc1 RELOAD
RBACK:
    v_add_f32 v11, v11, v90
    v_add_f32 v11, v11, v102
    v_add_f32 v11, v11, v114
    v_rcp_f32 v12, v11
    v_lshlrev_b32 v14, 16, v104
    v_add_f32 v240, v240, v14
    v_and_b32 v15, s81, v104
    v_add_f32 v241, v241, v15
    v_lshlrev_b32 v14, 16, v105
    v_add_f32 v242, v242, v14
    v_and_b32 v15, s81, v105
    v_add_f32 v243, v243, v15
    v_lshlrev_b32 v14, 16, v106
    v_add_f32 v244, v244, v14
    v_and_b32 v15, s81, v106
    v_add_f32 v245, v245, v15
    v_lshlrev_b32 v14, 16, v108
    v_add_f32 v246, v246, v14
    v_and_b32 v15, s81, v108
    v_add_f32 v247, v247, v15
    v_lshlrev_b32 v14, 16, v109
    v_add_f32 v248, v248, v14
    v_and_b32 v15, s81, v109
    v_add_f32 v249, v249, v15
    v_lshlrev_b32 v14, 16, v110
    v_add_f32 v250, v250, v14
    v_and_b32 v15, s81, v110
    v_add_f32 v251, v251, v15
    v_lshlrev_b32 v14, 16, v112
    v_add_f32 v252, v252, v14
    v_and_b32 v15, s81, v112
    v_add_f32 v253, v253, v15
    v_lshlrev_b32 v14, 16, v113
    v_add_f32 v254, v254, v14
    v_and_b32 v15, s81, v113
    v_add_f32 v255, v255, v15
    v_mul_f32 v240, v240, v12
    v_mul_f32 v241, v241, v12
    v_mul_f32 v242, v242, v12
    v_mul_f32 v243, v243, v12
    v_mul_f32 v244, v244, v12
    v_mul_f32 v245, v245, v12
    v_mul_f32 v246, v246, v12
    v_mul_f32 v247, v247, v12
    v_mul_f32 v248, v248, v12
    v_mul_f32 v249, v249, v12
    v_mul_f32 v250, v250, v12
    v_mul_f32 v251, v251, v12
    v_mul_f32 v252, v252, v12
    v_mul_f32 v253, v253, v12
    v_mul_f32 v254, v254, v12
    v_mul_f32 v255, v255, v12
OUTST:
    v_cvt_pk_bf16_f32 v48, v240, v241
    v_cvt_pk_bf16_f32 v49, v242, v243
    v_cvt_pk_bf16_f32 v50, v244, v245
    v_cvt_pk_bf16_f32 v51, v246, v247
    v_cvt_pk_bf16_f32 v52, v248, v249
    v_cvt_pk_bf16_f32 v53, v250, v251
    v_cvt_pk_bf16_f32 v54, v252, v253
    v_cvt_pk_bf16_f32 v55, v254, v255
    v_permlane32_swap_b32 v48, v50
    v_permlane32_swap_b32 v49, v51
    v_permlane32_swap_b32 v52, v54
    v_permlane32_swap_b32 v53, v55
    buffer_store_dwordx4 v[48:51], v5, s[36:39], s80 offen
    buffer_store_dwordx4 v[52:55], v5, s[36:39], s80 offen offset:32
    s_or_b32 s89, s50, s48
    s_cmp_lg_u32 s89, 0
    s_cbranch_scc1 A_end
    v_mov_b32 v6, s56
    v_mov_b32 v7, s57
    v_mov_b32 v12, s94
    s_mov_b64 exec, 1
    buffer_store_dwordx2 v[6:7], v12, s[32:35], 0 offen sc1
A_end:
    s_endpgm
RELOAD:
    buffer_load_dwordx4 v[80:83], v1, s[32:35], s77 offen sc1
    buffer_load_dwordx4 v[84:87], v1, s[32:35], s77 offen offset:1024 sc1
    buffer_load_dwordx4 v[88:91], v1, s[32:35], s77 offen offset:2048 sc1
    buffer_load_dwordx4 v[92:95], v1, s[32:35], s78 offen sc1
    buffer_load_dwordx4 v[96:99], v1, s[32:35], s78 offen offset:1024 sc1
    buffer_load_dwordx4 v[100:103], v1, s[32:35], s78 offen offset:2048 sc1
    buffer_load_dwordx4 v[104:107], v1, s[32:35], s79 offen sc1
    buffer_load_dwordx4 v[108:111], v1, s[32:35], s79 offen offset:1024 sc1
    buffer_load_dwordx4 v[112:115], v1, s[32:35], s79 offen offset:2048 sc1
    s_or_b32 s42, s56, 1
    s_mov_b64 s[84:85], 0
    s_mov_b64 s[86:87], 0
    s_waitcnt vmcnt(0)
    v_cmp_ne_u32 vcc, v83, v87
    s_or_b64 s[84:85], s[84:85], vcc
    v_cmp_ne_u32 vcc, v83, v91
    s_or_b64 s[84:85], s[84:85], vcc
    v_or_b32 v12, 1, v83
    v_cmp_ne_u32 vcc, s42, v12
    s_or_b64 s[84:85], s[84:85], vcc
    v_cmp_ne_u32 vcc, s56, v83
    s_or_b64 s[86:87], s[86:87], vcc
    v_cmp_ne_u32 vcc, v95, v99
    s_or_b64 s[84:85], s[84:85], vcc
    v_cmp_ne_u32 vcc, v95, v103
    s_or_b64 s[84:85], s[84:85], vcc
    v_or_b32 v12, 1, v95
    v_cmp_ne_u32 vcc, s42, v12
    s_or_b64 s[84:85], s[84:85], vcc
    v_cmp_ne_u32 vcc, s56, v95
    s_or_b64 s[86:87], s[86:87], vcc
    v_cmp_ne_u32 vcc, v107, v111
    s_or_b64 s[84:85], s[84:85], vcc
    v_cmp_ne_u32 vcc, v107, v115
    s_or_b64 s[84:85], s[84:85], vcc
    v_or_b32 v12, 1, v107
    v_cmp_ne_u32 vcc, s42, v12
    s_or_b64 s[84:85], s[84:85], vcc
    v_cmp_ne_u32 vcc, s56, v107
    s_or_b64 s[86:87], s[86:87], vcc
    s_add_u32 s88, s88, 1
    s_cmp_gt_u32 s88, 100000
    s_cbranch_scc1 RELOAD_GO
    s_cmp_lg_u64 s[84:85], 0
    s_cbranch_scc1 RELOAD
RELOAD_GO:
    s_cmp_lg_u64 s[86:87], 0
    s_cbranch_scc1 GENERAL
    s_cmp_lg_u32 s40, 0
    s_cbranch_scc1 GENERAL
    v_lshlrev_b32 v240, 16, v80
    v_lshlrev_b32 v14, 16, v92
    v_add_f32 v240, v240, v14
    v_add_f32 v240, v240, v224
    v_and_b32 v241, s81, v80
    v_and_b32 v14, s81, v92
    v_add_f32 v241, v241, v14
    v_add_f32 v241, v241, v225
    v_lshlrev_b32 v242, 16, v81
    v_lshlrev_b32 v14, 16, v93
    v_add_f32 v242, v242, v14
    v_add_f32 v242, v242, v226
    v_and_b32 v243, s81, v81
    v_and_b32 v14, s81, v93
    v_add_f32 v243, v243, v14
    v_add_f32 v243, v243, v227
    v_lshlrev_b32 v244, 16, v82
    v_lshlrev_b32 v14, 16, v94
    v_add_f32 v244, v244, v14
    v_add_f32 v244, v244, v228
    v_and_b32 v245, s81, v82
    v_and_b32 v14, s81, v94
    v_add_f32 v245, v245, v14
    v_add_f32 v245, v245, v229
    v_lshlrev_b32 v246, 16, v84
    v_lshlrev_b32 v14, 16, v96
    v_add_f32 v246, v246, v14
    v_add_f32 v246, v246, v230
    v_and_b32 v247, s81, v84
    v_and_b32 v14, s81, v96
    v_add_f32 v247, v247, v14
    v_add_f32 v247, v247, v231
    v_lshlrev_b32 v248, 16, v85
    v_lshlrev_b32 v14, 16, v97
    v_add_f32 v248, v248, v14
    v_add_f32 v248, v248, v232
    v_and_b32 v249, s81, v85
    v_and_b32 v14, s81, v97
    v_add_f32 v249, v249, v14
    v_add_f32 v249, v249, v233
    v_lshlrev_b32 v250, 16, v86
    v_lshlrev_b32 v14, 16, v98
    v_add_f32 v250, v250, v14
    v_add_f32 v250, v250, v234
    v_and_b32 v251, s81, v86
    v_and_b32 v14, s81, v98
    v_add_f32 v251, v251, v14
    v_add_f32 v251, v251, v235
    v_lshlrev_b32 v252, 16, v88
    v_lshlrev_b32 v14, 16, v100
    v_add_f32 v252, v252, v14
    v_add_f32 v252, v252, v236
    v_and_b32 v253, s81, v88
    v_and_b32 v14, s81, v100
    v_add_f32 v253, v253, v14
    v_add_f32 v253, v253, v237
    v_lshlrev_b32 v254, 16, v89
    v_lshlrev_b32 v14, 16, v101
    v_add_f32 v254, v254, v14
    v_add_f32 v254, v254, v238
    v_and_b32 v255, s81, v89
    v_and_b32 v14, s81, v101
    v_add_f32 v255, v255, v14
    v_add_f32 v255, v255, v239
    s_branch RBACK
GENERAL:
    v_log_f32 v51, v11
    v_rcp_f32 v55, v11
    v_log_f32 v48, v90
    v_rcp_f32 v52, v90
    v_log_f32 v49, v102
    v_rcp_f32 v53, v102
    v_log_f32 v50, v114
    v_rcp_f32 v54, v114
    v_add_f32 v51, v51, v7
    v_cmp_ne_u32 vcc, s56, v83
    s_nop 1
    v_cndmask_b32 v48, v48, v90, vcc
    v_cndmask_b32_e64 v52, v52, 1.0, vcc
    v_cmp_ne_u32 vcc, s56, v95
    s_nop 1
    v_cndmask_b32 v49, v49, v102, vcc
    v_cndmask_b32_e64 v53, v53, 1.0, vcc
    v_cmp_ne_u32 vcc, s56, v107
    s_nop 1
    v_cndmask_b32 v50, v50, v114, vcc
    v_cndmask_b32_e64 v54, v54, 1.0, vcc
    v_max3_f32 v60, v48, v49, v50
    v_max_f32 v60, v60, v51
    v_sub_f32 v56, v48, v60
    v_sub_f32 v57, v49, v60
    v_sub_f32 v58, v50, v60
    v_sub_f32 v59, v51, v60
    v_exp_f32 v56, v56
    v_exp_f32 v57, v57
    v_exp_f32 v58, v58
    v_exp_f32 v59, v59
    s_nop 0
    v_add_f32 v61, v56, v57
    v_add_f32 v62, v58, v59
    v_add_f32 v61, v61, v62
    v_rcp_f32 v61, v61
    s_nop 0
    v_mul_f32 v56, v56, v52
    v_mul_f32 v56, v56, v61
    v_mul_f32 v57, v57, v53
    v_mul_f32 v57, v57, v61
    v_mul_f32 v58, v58, v54
    v_mul_f32 v58, v58, v61
    v_mul_f32 v59, v59, v55
    v_mul_f32 v59, v59, v61
    v_mul_f32 v240, v224, v59
    v_mul_f32 v241, v225, v59
    v_mul_f32 v242, v226, v59
    v_mul_f32 v243, v227, v59
    v_mul_f32 v244, v228, v59
    v_mul_f32 v245, v229, v59
    v_mul_f32 v246, v230, v59
    v_mul_f32 v247, v231, v59
    v_mul_f32 v248, v232, v59
    v_mul_f32 v249, v233, v59
    v_mul_f32 v250, v234, v59
    v_mul_f32 v251, v235, v59
    v_mul_f32 v252, v236, v59
    v_mul_f32 v253, v237, v59
    v_mul_f32 v254, v238, v59
    v_mul_f32 v255, v239, v59
    v_lshlrev_b32 v64, 16, v80
    v_and_b32 v65, s81, v80
    v_fmac_f32 v240, v64, v56
    v_fmac_f32 v241, v65, v56
    v_lshlrev_b32 v64, 16, v81
    v_and_b32 v65, s81, v81
    v_fmac_f32 v242, v64, v56
    v_fmac_f32 v243, v65, v56
    v_lshlrev_b32 v64, 16, v82
    v_and_b32 v65, s81, v82
    v_fmac_f32 v244, v64, v56
    v_fmac_f32 v245, v65, v56
    v_lshlrev_b32 v64, 16, v84
    v_and_b32 v65, s81, v84
    v_fmac_f32 v246, v64, v56
    v_fmac_f32 v247, v65, v56
    v_lshlrev_b32 v64, 16, v85
    v_and_b32 v65, s81, v85
    v_fmac_f32 v248, v64, v56
    v_fmac_f32 v249, v65, v56
    v_lshlrev_b32 v64, 16, v86
    v_and_b32 v65, s81, v86
    v_fmac_f32 v250, v64, v56
    v_fmac_f32 v251, v65, v56
    v_lshlrev_b32 v64, 16, v88
    v_and_b32 v65, s81, v88
    v_fmac_f32 v252, v64, v56
    v_fmac_f32 v253, v65, v56
    v_lshlrev_b32 v64, 16, v89
    v_and_b32 v65, s81, v89
    v_fmac_f32 v254, v64, v56
    v_fmac_f32 v255, v65, v56
    v_lshlrev_b32 v64, 16, v92
    v_and_b32 v65, s81, v92
    v_fmac_f32 v240, v64, v57
    v_fmac_f32 v241, v65, v57
    v_lshlrev_b32 v64, 16, v93
    v_and_b32 v65, s81, v93
    v_fmac_f32 v242, v64, v57
    v_fmac_f32 v243, v65, v57
    v_lshlrev_b32 v64, 16, v94
    v_and_b32 v65, s81, v94
    v_fmac_f32 v244, v64, v57
    v_fmac_f32 v245, v65, v57
    v_lshlrev_b32 v64, 16, v96
    v_and_b32 v65, s81, v96
    v_fmac_f32 v246, v64, v57
    v_fmac_f32 v247, v65, v57
    v_lshlrev_b32 v64, 16, v97
    v_and_b32 v65, s81, v97
    v_fmac_f32 v248, v64, v57
    v_fmac_f32 v249, v65, v57
    v_lshlrev_b32 v64, 16, v98
    v_and_b32 v65, s81, v98
    v_fmac_f32 v250, v64, v57
    v_fmac_f32 v251, v65, v57
    v_lshlrev_b32 v64, 16, v100
    v_and_b32 v65, s81, v100
    v_fmac_f32 v252, v64, v57
    v_fmac_f32 v253, v65, v57
    v_lshlrev_b32 v64, 16, v101
    v_and_b32 v65, s81, v101
    v_fmac_f32 v254, v64, v57
    v_fmac_f32 v255, v65, v57
    v_lshlrev_b32 v64, 16, v104
    v_and_b32 v65, s81, v104
    v_fmac_f32 v240, v64, v58
    v_fmac_f32 v241, v65, v58
    v_lshlrev_b32 v64, 16, v105
    v_and_b32 v65, s81, v105
    v_fmac_f32 v242, v64, v58
    v_fmac_f32 v243, v65, v58
    v_lshlrev_b32 v64, 16, v106
    v_and_b32 v65, s81, v106
    v_fmac_f32 v244, v64, v58
    v_fmac_f32 v245, v65, v58
    v_lshlrev_b32 v64, 16, v108
    v_and_b32 v65, s81, v108
    v_fmac_f32 v246, v64, v58
    v_fmac_f32 v247, v65, v58
    v_lshlrev_b32 v64, 16, v109
    v_and_b32 v65, s81, v109
    v_fmac_f32 v248, v64, v58
    v_fmac_f32 v249, v65, v58
    v_lshlrev_b32 v64, 16, v110
    v_and_b32 v65, s81, v110
    v_fmac_f32 v250, v64, v58
    v_fmac_f32 v251, v65, v58
    v_lshlrev_b32 v64, 16, v112
    v_and_b32 v65, s81, v112
    v_fmac_f32 v252, v64, v58
    v_fmac_f32 v253, v65, v58
    v_lshlrev_b32 v64, 16, v113
    v_and_b32 v65, s81, v113
    v_fmac_f32 v254, v64, v58
    v_fmac_f32 v255, v65, v58
    s_branch OUTST
SLOW_0:
SLOW_1:
SLOW_2:
SLOW_3:
    s_waitcnt vmcnt(0) lgkmcnt(0)
    s_barrier
    s_mov_b32 s40, 1
    s_mov_b32 s41, 0
    s_xor_b32 s89, s56, 1
    v_mov_b32 v31, s89
    v_mov_b32 v35, s89
    v_mov_b32 v39, s89
    v_and_b32 v9, 31, v0
    v_lshlrev_b32 v9, 2, v9
    s_lshl_b32 s89, s48, 8
    s_add_u32 s89, s89, 49664
    v_add_u32 v9, s89, v9
    v_add_u32 v11, 57856, v1
    s_lshl_b32 s89, s48, 11
    v_add_u32 v10, s89, v11
SLOW_LOOP:
    s_mul_i32 s89, s41, 8320
    v_add_u32 v8, s89, v1
    ds_read_b128 v[160:163], v8 offset:0
    ds_read_b128 v[164:167], v8 offset:1040
    ds_read_b128 v[168:171], v8 offset:2080
    ds_read_b128 v[172:175], v8 offset:3120
    ds_read_b128 v[176:179], v8 offset:4160
    ds_read_b128 v[180:183], v8 offset:5200
    ds_read_b128 v[184:187], v8 offset:6240
    ds_read_b128 v[188:191], v8 offset:7280
    s_waitcnt lgkmcnt(7)
    v_mfma_f32_32x32x16_bf16 v[48:63], a[0:3], v[160:163], 0
    s_waitcnt lgkmcnt(6)
    v_mfma_f32_32x32x16_bf16 v[48:63], a[4:7], v[164:167], v[48:63]
    s_waitcnt lgkmcnt(5)
    v_mfma_f32_32x32x16_bf16 v[48:63], a[8:11], v[168:171], v[48:63]
    s_waitcnt lgkmcnt(4)
    v_mfma_f32_32x32x16_bf16 v[48:63], a[12:15], v[172:175], v[48:63]
    s_waitcnt lgkmcnt(3)
    v_mfma_f32_32x32x16_bf16 v[48:63], a[16:19], v[176:179], v[48:63]
    s_waitcnt lgkmcnt(2)
    v_mfma_f32_32x32x16_bf16 v[48:63], a[20:23], v[180:183], v[48:63]
    s_waitcnt lgkmcnt(1)
    v_mfma_f32_32x32x16_bf16 v[48:63], a[24:27], v[184:187], v[48:63]
    s_waitcnt lgkmcnt(0)
    v_mfma_f32_32x32x16_bf16 v[48:63], a[28:31], v[188:191], v[48:63]
    v_mfma_f32_32x32x16_bf16 v[64:79], a[32:35], v[160:163], 0
    v_mfma_f32_32x32x16_bf16 v[64:79], a[36:39], v[164:167], v[64:79]
    v_mfma_f32_32x32x16_bf16 v[64:79], a[40:43], v[168:171], v[64:79]
    v_mfma_f32_32x32x16_bf16 v[64:79], a[44:47], v[172:175], v[64:79]
    v_mfma_f32_32x32x16_bf16 v[64:79], a[48:51], v[176:179], v[64:79]
    v_mfma_f32_32x32x16_bf16 v[64:79], a[52:55], v[180:183], v[64:79]
    v_mfma_f32_32x32x16_bf16 v[64:79], a[56:59], v[184:187], v[64:79]
    v_mfma_f32_32x32x16_bf16 v[64:79], a[60:63], v[188:191], v[64:79]
    v_mfma_f32_32x32x16_bf16 v[80:95], a[64:67], v[160:163], 0
    v_mfma_f32_32x32x16_bf16 v[80:95], a[68:71], v[164:167], v[80:95]
    v_mfma_f32_32x32x16_bf16 v[80:95], a[72:75], v[168:171], v[80:95]
    v_mfma_f32_32x32x16_bf16 v[80:95], a[76:79], v[172:175], v[80:95]
    v_mfma_f32_32x32x16_bf16 v[80:95], a[80:83], v[176:179], v[80:95]
    v_mfma_f32_32x32x16_bf16 v[80:95], a[84:87], v[180:183], v[80:95]
    v_mfma_f32_32x32x16_bf16 v[80:95], a[88:91], v[184:187], v[80:95]
    v_mfma_f32_32x32x16_bf16 v[80:95], a[92:95], v[188:191], v[80:95]
    v_mfma_f32_32x32x16_bf16 v[96:111], a[96:99], v[160:163], 0
    v_mfma_f32_32x32x16_bf16 v[96:111], a[100:103], v[164:167], v[96:111]
    v_mfma_f32_32x32x16_bf16 v[96:111], a[104:107], v[168:171], v[96:111]
    v_mfma_f32_32x32x16_bf16 v[96:111], a[108:111], v[172:175], v[96:111]
    v_mfma_f32_32x32x16_bf16 v[96:111], a[112:115], v[176:179], v[96:111]
    v_mfma_f32_32x32x16_bf16 v[96:111], a[116:119], v[180:183], v[96:111]
    v_mfma_f32_32x32x16_bf16 v[96:111], a[120:123], v[184:187], v[96:111]
    v_mfma_f32_32x32x16_bf16 v[96:111], a[124:127], v[188:191], v[96:111]
    v_max3_f32 v12, v48, v49, v50
    v_max3_f32 v12, v12, v51, v52
    v_max3_f32 v12, v12, v53, v54
    v_max3_f32 v12, v12, v55, v56
    v_max3_f32 v12, v12, v57, v58
    v_max3_f32 v12, v12, v59, v60
    v_max3_f32 v12, v12, v61, v62
    v_max3_f32 v12, v12, v63, v64
    v_max3_f32 v12, v12, v65, v66
    v_max3_f32 v12, v12, v67, v68
    v_max3_f32 v12, v12, v69, v70
    v_max3_f32 v12, v12, v71, v72
    v_max3_f32 v12, v12, v73, v74
    v_max3_f32 v12, v12, v75, v76
    v_max3_f32 v12, v12, v77, v78
    v_max3_f32 v12, v12, v79, v80
    v_max3_f32 v12, v12, v81, v82
    v_max3_f32 v12, v12, v83, v84
    v_max3_f32 v12, v12, v85, v86
    v_max3_f32 v12, v12, v87, v88
    v_max3_f32 v12, v12, v89, v90
    v_max3_f32 v12, v12, v91, v92
    v_max3_f32 v12, v12, v93, v94
    v_max3_f32 v12, v12, v95, v96
    v_max3_f32 v12, v12, v97, v98
    v_max3_f32 v12, v12, v99, v100
    v_max3_f32 v12, v12, v101, v102
    v_max3_f32 v12, v12, v103, v104
    v_max3_f32 v12, v12, v105, v106
    v_max3_f32 v12, v12, v107, v108
    v_max3_f32 v12, v12, v109, v110
    v_max_f32 v12, v12, v111
    v_mov_b32 v13, v12
    s_nop 1
    v_permlane32_swap_b32 v12, v13
    s_nop 1
    v_max_f32 v12, v12, v13
    ds_write_b32 v9, v12 offset:0
    s_waitcnt lgkmcnt(0)
    s_barrier
    ds_read2st64_b32 v[14:15], v4 offset0:0 offset1:1
    ds_read2st64_b32 v[16:17], v4 offset0:2 offset1:3
    s_waitcnt lgkmcnt(0)
    v_max3_f32 v12, v14, v15, v16
    v_max_f32 v12, v12, v17
    v_sub_f32 v48, v48, v12
    v_sub_f32 v49, v49, v12
    v_sub_f32 v50, v50, v12
    v_sub_f32 v51, v51, v12
    v_sub_f32 v52, v52, v12
    v_sub_f32 v53, v53, v12
    v_sub_f32 v54, v54, v12
    v_sub_f32 v55, v55, v12
    v_sub_f32 v56, v56, v12
    v_sub_f32 v57, v57, v12
    v_sub_f32 v58, v58, v12
    v_sub_f32 v59, v59, v12
    v_sub_f32 v60, v60, v12
    v_sub_f32 v61, v61, v12
    v_sub_f32 v62, v62, v12
    v_sub_f32 v63, v63, v12
    v_sub_f32 v64, v64, v12
    v_sub_f32 v65, v65, v12
    v_sub_f32 v66, v66, v12
    v_sub_f32 v67, v67, v12
    v_sub_f32 v68, v68, v12
    v_sub_f32 v69, v69, v12
    v_sub_f32 v70, v70, v12
    v_sub_f32 v71, v71, v12
    v_sub_f32 v72, v72, v12
    v_sub_f32 v73, v73, v12
    v_sub_f32 v74, v74, v12
    v_sub_f32 v75, v75, v12
    v_sub_f32 v76, v76, v12
    v_sub_f32 v77, v77, v12
    v_sub_f32 v78, v78, v12
    v_sub_f32 v79, v79, v12
    v_sub_f32 v80, v80, v12
    v_sub_f32 v81, v81, v12
    v_sub_f32 v82, v82, v12
    v_sub_f32 v83, v83, v12
    v_sub_f32 v84, v84, v12
    v_sub_f32 v85, v85, v12
    v_sub_f32 v86, v86, v12
    v_sub_f32 v87, v87, v12
    v_sub_f32 v88, v88, v12
    v_sub_f32 v89, v89, v12
    v_sub_f32 v90, v90, v12
    v_sub_f32 v91, v91, v12
    v_sub_f32 v92, v92, v12
    v_sub_f32 v93, v93, v12
    v_sub_f32 v94, v94, v12
    v_sub_f32 v95, v95, v12
    v_sub_f32 v96, v96, v12
    v_sub_f32 v97, v97, v12
    v_sub_f32 v98, v98, v12
    v_sub_f32 v99, v99, v12
    v_sub_f32 v100, v100, v12
    v_sub_f32 v101, v101, v12
    v_sub_f32 v102, v102, v12
    v_sub_f32 v103, v103, v12
    v_sub_f32 v104, v104, v12
    v_sub_f32 v105, v105, v12
    v_sub_f32 v106, v106, v12
    v_sub_f32 v107, v107, v12
    v_sub_f32 v108, v108, v12
    v_sub_f32 v109, v109, v12
    v_sub_f32 v110, v110, v12
    v_sub_f32 v111, v111, v12
    v_exp_f32 v48, v48
    v_exp_f32 v49, v49
    v_exp_f32 v50, v50
    v_exp_f32 v51, v51
    v_exp_f32 v52, v52
    v_exp_f32 v53, v53
    v_exp_f32 v54, v54
    v_exp_f32 v55, v55
    v_exp_f32 v56, v56
    v_exp_f32 v57, v57
    v_exp_f32 v58, v58
    v_exp_f32 v59, v59
    v_exp_f32 v60, v60
    v_exp_f32 v61, v61
    v_exp_f32 v62, v62
    v_exp_f32 v63, v63
    v_exp_f32 v64, v64
    v_exp_f32 v65, v65
    v_exp_f32 v66, v66
    v_exp_f32 v67, v67
    v_exp_f32 v68, v68
    v_exp_f32 v69, v69
    v_exp_f32 v70, v70
    v_exp_f32 v71, v71
    v_exp_f32 v72, v72
    v_exp_f32 v73, v73
    v_exp_f32 v74, v74
    v_exp_f32 v75, v75
    v_exp_f32 v76, v76
    v_exp_f32 v77, v77
    v_exp_f32 v78, v78
    v_exp_f32 v79, v79
    v_exp_f32 v80, v80
    v_exp_f32 v81, v81
    v_exp_f32 v82, v82
    v_exp_f32 v83, v83
    v_exp_f32 v84, v84
    v_exp_f32 v85, v85
    v_exp_f32 v86, v86
    v_exp_f32 v87, v87
    v_exp_f32 v88, v88
    v_exp_f32 v89, v89
    v_exp_f32 v90, v90
    v_exp_f32 v91, v91
    v_exp_f32 v92, v92
    v_exp_f32 v93, v93
    v_exp_f32 v94, v94
    v_exp_f32 v95, v95
    v_exp_f32 v96, v96
    v_exp_f32 v97, v97
    v_exp_f32 v98, v98
    v_exp_f32 v99, v99
    v_exp_f32 v100, v100
    v_exp_f32 v101, v101
    v_exp_f32 v102, v102
    v_exp_f32 v103, v103
    v_exp_f32 v104, v104
    v_exp_f32 v105, v105
    v_exp_f32 v106, v106
    v_exp_f32 v107, v107
    v_exp_f32 v108, v108
    v_exp_f32 v109, v109
    v_exp_f32 v110, v110
    v_exp_f32 v111, v111
    v_mov_b32 v13, v48
    v_add_f32 v13, v13, v49
    v_add_f32 v13, v13, v50
    v_add_f32 v13, v13, v51
    v_add_f32 v13, v13, v52
    v_add_f32 v13, v13, v53
    v_add_f32 v13, v13, v54
    v_add_f32 v13, v13, v55
    v_add_f32 v13, v13, v56
    v_add_f32 v13, v13, v57
    v_add_f32 v13, v13, v58
    v_add_f32 v13, v13, v59
    v_add_f32 v13, v13, v60
    v_add_f32 v13, v13, v61
    v_add_f32 v13, v13, v62
    v_add_f32 v13, v13, v63
    v_add_f32 v13, v13, v64
    v_add_f32 v13, v13, v65
    v_add_f32 v13, v13, v66
    v_add_f32 v13, v13, v67
    v_add_f32 v13, v13, v68
    v_add_f32 v13, v13, v69
    v_add_f32 v13, v13, v70
    v_add_f32 v13, v13, v71
    v_add_f32 v13, v13, v72
    v_add_f32 v13, v13, v73
    v_add_f32 v13, v13, v74
    v_add_f32 v13, v13, v75
    v_add_f32 v13, v13, v76
    v_add_f32 v13, v13, v77
    v_add_f32 v13, v13, v78
    v_add_f32 v13, v13, v79
    v_add_f32 v13, v13, v80
    v_add_f32 v13, v13, v81
    v_add_f32 v13, v13, v82
    v_add_f32 v13, v13, v83
    v_add_f32 v13, v13, v84
    v_add_f32 v13, v13, v85
    v_add_f32 v13, v13, v86
    v_add_f32 v13, v13, v87
    v_add_f32 v13, v13, v88
    v_add_f32 v13, v13, v89
    v_add_f32 v13, v13, v90
    v_add_f32 v13, v13, v91
    v_add_f32 v13, v13, v92
    v_add_f32 v13, v13, v93
    v_add_f32 v13, v13, v94
    v_add_f32 v13, v13, v95
    v_add_f32 v13, v13, v96
    v_add_f32 v13, v13, v97
    v_add_f32 v13, v13, v98
    v_add_f32 v13, v13, v99
    v_add_f32 v13, v13, v100
    v_add_f32 v13, v13, v101
    v_add_f32 v13, v13, v102
    v_add_f32 v13, v13, v103
    v_add_f32 v13, v13, v104
    v_add_f32 v13, v13, v105
    v_add_f32 v13, v13, v106
    v_add_f32 v13, v13, v107
    v_add_f32 v13, v13, v108
    v_add_f32 v13, v13, v109
    v_add_f32 v13, v13, v110
    v_add_f32 v13, v13, v111
    v_cvt_pk_bf16_f32 v192, v48, v49
    v_cvt_pk_bf16_f32 v193, v50, v51
    v_cvt_pk_bf16_f32 v194, v52, v53
    v_cvt_pk_bf16_f32 v195, v54, v55
    v_cvt_pk_bf16_f32 v196, v56, v57
    v_cvt_pk_bf16_f32 v197, v58, v59
    v_cvt_pk_bf16_f32 v198, v60, v61
    v_cvt_pk_bf16_f32 v199, v62, v63
    v_cvt_pk_bf16_f32 v200, v64, v65
    v_cvt_pk_bf16_f32 v201, v66, v67
    v_cvt_pk_bf16_f32 v202, v68, v69
    v_cvt_pk_bf16_f32 v203, v70, v71
    v_cvt_pk_bf16_f32 v204, v72, v73
    v_cvt_pk_bf16_f32 v205, v74, v75
    v_cvt_pk_bf16_f32 v206, v76, v77
    v_cvt_pk_bf16_f32 v207, v78, v79
    v_cvt_pk_bf16_f32 v208, v80, v81
    v_cvt_pk_bf16_f32 v209, v82, v83
    v_cvt_pk_bf16_f32 v210, v84, v85
    v_cvt_pk_bf16_f32 v211, v86, v87
    v_cvt_pk_bf16_f32 v212, v88, v89
    v_cvt_pk_bf16_f32 v213, v90, v91
    v_cvt_pk_bf16_f32 v214, v92, v93
    v_cvt_pk_bf16_f32 v215, v94, v95
    v_cvt_pk_bf16_f32 v216, v96, v97
    v_cvt_pk_bf16_f32 v217, v98, v99
    v_cvt_pk_bf16_f32 v218, v100, v101
    v_cvt_pk_bf16_f32 v219, v102, v103
    v_cvt_pk_bf16_f32 v220, v104, v105
    v_cvt_pk_bf16_f32 v221, v106, v107
    v_cvt_pk_bf16_f32 v222, v108, v109
    v_cvt_pk_bf16_f32 v223, v110, v111
    ds_write_b128 v10, v[192:195] offset:0
    ds_write_b128 v10, v[196:199] offset:1024
    ds_write_b128 v10, v[200:203] offset:8192
    ds_write_b128 v10, v[204:207] offset:9216
    ds_write_b128 v10, v[208:211] offset:16384
    ds_write_b128 v10, v[212:215] offset:17408
    ds_write_b128 v10, v[216:219] offset:24576
    ds_write_b128 v10, v[220:223] offset:25600
    v_mov_b32 v14, v13
    s_nop 1
    v_permlane32_swap_b32 v13, v14
    s_nop 1
    v_add_f32 v13, v13, v14
    ds_write_b32 v9, v13 offset:1024
    s_waitcnt lgkmcnt(0)
    s_barrier
    ds_read2st64_b32 v[14:15], v4 offset0:4 offset1:5
    ds_read2st64_b32 v[16:17], v4 offset0:6 offset1:7
    ds_read_b128 v[128:131], v11 offset:0
    ds_read_b128 v[132:135], v11 offset:1024
    ds_read_b128 v[136:139], v11 offset:2048
    ds_read_b128 v[140:143], v11 offset:3072
    ds_read_b128 v[144:147], v11 offset:4096
    ds_read_b128 v[148:151], v11 offset:5120
    ds_read_b128 v[152:155], v11 offset:6144
    ds_read_b128 v[156:159], v11 offset:7168
    s_waitcnt lgkmcnt(7)
    v_mfma_f32_32x32x16_bf16 v[224:239], a[128:131], v[128:131], 0
    s_waitcnt lgkmcnt(6)
    v_mfma_f32_32x32x16_bf16 v[224:239], a[132:135], v[132:135], v[224:239]
    s_waitcnt lgkmcnt(5)
    v_mfma_f32_32x32x16_bf16 v[224:239], a[136:139], v[136:139], v[224:239]
    s_waitcnt lgkmcnt(4)
    v_mfma_f32_32x32x16_bf16 v[224:239], a[140:143], v[140:143], v[224:239]
    s_waitcnt lgkmcnt(3)
    v_mfma_f32_32x32x16_bf16 v[224:239], a[144:147], v[144:147], v[224:239]
    s_waitcnt lgkmcnt(2)
    v_mfma_f32_32x32x16_bf16 v[224:239], a[148:151], v[148:151], v[224:239]
    s_waitcnt lgkmcnt(1)
    v_mfma_f32_32x32x16_bf16 v[224:239], a[152:155], v[152:155], v[224:239]
    s_waitcnt lgkmcnt(0)
    v_mfma_f32_32x32x16_bf16 v[224:239], a[156:159], v[156:159], v[224:239]
    ds_read_b128 v[128:131], v11 offset:8192
    ds_read_b128 v[132:135], v11 offset:9216
    ds_read_b128 v[136:139], v11 offset:10240
    ds_read_b128 v[140:143], v11 offset:11264
    ds_read_b128 v[144:147], v11 offset:12288
    ds_read_b128 v[148:151], v11 offset:13312
    ds_read_b128 v[152:155], v11 offset:14336
    ds_read_b128 v[156:159], v11 offset:15360
    s_waitcnt lgkmcnt(7)
    v_mfma_f32_32x32x16_bf16 v[224:239], a[160:163], v[128:131], v[224:239]
    s_waitcnt lgkmcnt(6)
    v_mfma_f32_32x32x16_bf16 v[224:239], a[164:167], v[132:135], v[224:239]
    s_waitcnt lgkmcnt(5)
    v_mfma_f32_32x32x16_bf16 v[224:239], a[168:171], v[136:139], v[224:239]
    s_waitcnt lgkmcnt(4)
    v_mfma_f32_32x32x16_bf16 v[224:239], a[172:175], v[140:143], v[224:239]
    s_waitcnt lgkmcnt(3)
    v_mfma_f32_32x32x16_bf16 v[224:239], a[176:179], v[144:147], v[224:239]
    s_waitcnt lgkmcnt(2)
    v_mfma_f32_32x32x16_bf16 v[224:239], a[180:183], v[148:151], v[224:239]
    s_waitcnt lgkmcnt(1)
    v_mfma_f32_32x32x16_bf16 v[224:239], a[184:187], v[152:155], v[224:239]
    s_waitcnt lgkmcnt(0)
    v_mfma_f32_32x32x16_bf16 v[224:239], a[188:191], v[156:159], v[224:239]
    ds_read_b128 v[128:131], v11 offset:16384
    ds_read_b128 v[132:135], v11 offset:17408
    ds_read_b128 v[136:139], v11 offset:18432
    ds_read_b128 v[140:143], v11 offset:19456
    ds_read_b128 v[144:147], v11 offset:20480
    ds_read_b128 v[148:151], v11 offset:21504
    ds_read_b128 v[152:155], v11 offset:22528
    ds_read_b128 v[156:159], v11 offset:23552
    s_waitcnt lgkmcnt(7)
    v_mfma_f32_32x32x16_bf16 v[224:239], a[192:195], v[128:131], v[224:239]
    s_waitcnt lgkmcnt(6)
    v_mfma_f32_32x32x16_bf16 v[224:239], a[196:199], v[132:135], v[224:239]
    s_waitcnt lgkmcnt(5)
    v_mfma_f32_32x32x16_bf16 v[224:239], a[200:203], v[136:139], v[224:239]
    s_waitcnt lgkmcnt(4)
    v_mfma_f32_32x32x16_bf16 v[224:239], a[204:207], v[140:143], v[224:239]
    s_waitcnt lgkmcnt(3)
    v_mfma_f32_32x32x16_bf16 v[224:239], a[208:211], v[144:147], v[224:239]
    s_waitcnt lgkmcnt(2)
    v_mfma_f32_32x32x16_bf16 v[224:239], a[212:215], v[148:151], v[224:239]
    s_waitcnt lgkmcnt(1)
    v_mfma_f32_32x32x16_bf16 v[224:239], a[216:219], v[152:155], v[224:239]
    s_waitcnt lgkmcnt(0)
    v_mfma_f32_32x32x16_bf16 v[224:239], a[220:223], v[156:159], v[224:239]
    ds_read_b128 v[128:131], v11 offset:24576
    ds_read_b128 v[132:135], v11 offset:25600
    ds_read_b128 v[136:139], v11 offset:26624
    ds_read_b128 v[140:143], v11 offset:27648
    ds_read_b128 v[144:147], v11 offset:28672
    ds_read_b128 v[148:151], v11 offset:29696
    ds_read_b128 v[152:155], v11 offset:30720
    ds_read_b128 v[156:159], v11 offset:31744
    s_waitcnt lgkmcnt(7)
    v_mfma_f32_32x32x16_bf16 v[224:239], a[224:227], v[128:131], v[224:239]
    s_waitcnt lgkmcnt(6)
    v_mfma_f32_32x32x16_bf16 v[224:239], a[228:231], v[132:135], v[224:239]
    s_waitcnt lgkmcnt(5)
    v_mfma_f32_32x32x16_bf16 v[224:239], a[232:235], v[136:139], v[224:239]
    s_waitcnt lgkmcnt(4)
    v_mfma_f32_32x32x16_bf16 v[224:239], a[236:239], v[140:143], v[224:239]
    s_waitcnt lgkmcnt(3)
    v_mfma_f32_32x32x16_bf16 v[224:239], a[240:243], v[144:147], v[224:239]
    s_waitcnt lgkmcnt(2)
    v_mfma_f32_32x32x16_bf16 v[224:239], a[244:247], v[148:151], v[224:239]
    s_waitcnt lgkmcnt(1)
    v_mfma_f32_32x32x16_bf16 v[224:239], a[248:251], v[152:155], v[224:239]
    s_waitcnt lgkmcnt(0)
    v_mfma_f32_32x32x16_bf16 v[224:239], a[252:255], v[156:159], v[224:239]
    v_add_f32 v14, v14, v15
    v_add_f32 v16, v16, v17
    v_add_f32 v13, v14, v16
    s_cmp_eq_u32 s41, 3
    s_cbranch_scc1 SLOW_OWN
    v_rcp_f32 v14, v13
    v_log_f32 v15, v13
    s_nop 7
    s_nop 7
    v_mul_f32 v224, v224, v14
    v_mul_f32 v225, v225, v14
    v_mul_f32 v226, v226, v14
    v_mul_f32 v227, v227, v14
    v_mul_f32 v228, v228, v14
    v_mul_f32 v229, v229, v14
    v_mul_f32 v230, v230, v14
    v_mul_f32 v231, v231, v14
    v_mul_f32 v232, v232, v14
    v_mul_f32 v233, v233, v14
    v_mul_f32 v234, v234, v14
    v_mul_f32 v235, v235, v14
    v_mul_f32 v236, v236, v14
    v_mul_f32 v237, v237, v14
    v_mul_f32 v238, v238, v14
    v_mul_f32 v239, v239, v14
    v_cvt_pk_bf16_f32 v28, v224, v225
    v_cvt_pk_bf16_f32 v29, v226, v227
    v_cvt_pk_bf16_f32 v30, v228, v229
    v_cvt_pk_bf16_f32 v32, v230, v231
    v_cvt_pk_bf16_f32 v33, v232, v233
    v_cvt_pk_bf16_f32 v34, v234, v235
    v_cvt_pk_bf16_f32 v36, v236, v237
    v_cvt_pk_bf16_f32 v37, v238, v239
    v_add_f32 v38, v15, v12
    s_cmp_eq_u32 s41, 1
    s_cselect_b32 s89, s75, s74
    s_cmp_eq_u32 s41, 2
    s_cselect_b32 s89, s76, s89
    buffer_store_dwordx4 v[28:31], v1, s[32:35], s89 offen sc1
    buffer_store_dwordx4 v[32:35], v1, s[32:35], s89 offen offset:1024 sc1
    buffer_store_dwordx4 v[36:39], v1, s[32:35], s89 offen offset:2048 sc1
    s_waitcnt lgkmcnt(0)
    s_barrier
    s_add_u32 s41, s41, 1
    s_branch SLOW_LOOP
SLOW_OWN:
    s_nop 7
    s_nop 7
    v_mov_b32 v11, v13
    v_mov_b32 v7, v12
    s_branch RELOAD
.p2align 10
.fill 4096, 4, 0xbf810000
.section .rodata,"a"
.p2align 6
.amdhsa_kernel standalone__kv_cache_quant_pre_rope_vs_post_rope__prompt_kernel
  .amdhsa_next_free_vgpr 512
  .amdhsa_next_free_sgpr 102
  .amdhsa_accum_offset 256
  .amdhsa_group_segment_fixed_size 0
  .amdhsa_kernarg_size 112
  .amdhsa_user_sgpr_count 2
  .amdhsa_user_sgpr_kernarg_segment_ptr 1
  .amdhsa_system_sgpr_workgroup_id_x 1
  .amdhsa_float_denorm_mode_32 3
.end_amdhsa_kernel
```
